```python
import torch

def _softmax(x, axis=-1):
    return torch.softmax(x, dim=axis)
def _gelu(x):
    return torch.nn.functional.gelu(x, approximate="tanh")
def _silu(x):
    return torch.nn.functional.silu(x)
def _sigmoid(x):
    return torch.sigmoid(x)
def _layernorm(x, axis=-1, eps=1e-5):
    m = x.mean(dim=axis, keepdim=True)
    v = x.var(dim=axis, keepdim=True, unbiased=False)
    return (x - m) / torch.sqrt(v + eps)
def _scatter_add(tgt, idx, src, axis=0):
    return tgt.clone().index_add_(axis, idx, src)
def _segment_sum(src, seg, n):
    out = torch.zeros((n,) + src.shape[1:], dtype=src.dtype)
    return out.index_add_(0, seg, src)
def _pad(x, pw):
    flat = tuple(v for pair in reversed(pw) for v in pair)
    return torch.nn.functional.pad(x, flat)

kernel_name = 'sequential_preLN__ssm_conv_h3__moe_arch_mod__prompt'

def setup_inputs():

    _w = (lambda a: (lambda t: t.to(torch.bfloat16) if t.is_floating_point() else t)(torch.as_tensor(a)))
    def _A_setup():
        B, S, D = 1, 2048, 640
        ks = 4
        return {
            "q": _w((lambda *s: torch.randn(*s, dtype=torch.bfloat16) * 0.05)(B, S, D)),
            "k": _w((lambda *s: torch.randn(*s, dtype=torch.bfloat16) * 0.2)(B, S, D)),
            "v": _w((lambda *s: torch.randn(*s, dtype=torch.bfloat16) * 0.2)(B, S, D)),
            "shift_k": _w((lambda *s: torch.randn(*s, dtype=torch.bfloat16) * 0.2)(D, ks) * 0.5),
            "ssm_k": _w((lambda *s: torch.randn(*s, dtype=torch.bfloat16) * 0.8)(D, S) * (1.0 / S ** 0.5)),
            "ssm_D": _w((lambda *s: torch.randn(*s, dtype=torch.bfloat16) * 0.2)(D)),
        }
    _A_in = _A_setup()

    def _B_setup():
        B, S, D, F, C = 1, 2048, 640, 1728, 8
        return {
            "x": _w((lambda *s: torch.randn(*s, dtype=torch.bfloat16) * 0.05)(B, S, D)),
            "w_r": _w((lambda *s: torch.randn(*s, dtype=torch.bfloat16) * 0.05)(D)),
            "w_gate": _w((lambda *s: torch.randn(*s, dtype=torch.bfloat16) * 0.05)(D, F)),
            "w_up": _w((lambda *s: torch.randn(*s, dtype=torch.bfloat16) * 0.05)(D, F)),
            "w_down": _w((lambda *s: torch.randn(*s, dtype=torch.bfloat16) * 0.05)(F, D)),
        }
    _B_in = _B_setup()

    return {
        "A_q": _A_in["q"],
        "A_k": _A_in["k"],
        "A_v": _A_in["v"],
        "A_shift_k": _A_in["shift_k"],
        "A_ssm_k": _A_in["ssm_k"],
        "A_ssm_D": _A_in["ssm_D"],
        "B_x": _B_in["x"],
        "B_w_r": _B_in["w_r"],
        "B_w_gate": _B_in["w_gate"],
        "B_w_up": _B_in["w_up"],
        "B_w_down": _B_in["w_down"],
    }

def reference(A_q, A_k, A_v, A_shift_k, A_ssm_k, A_ssm_D, B_x, B_w_r, B_w_gate, B_w_up, B_w_down):
    def _A_ref(q, k, v, shift_k, ssm_k, ssm_D):
        B, S, D = q.shape
        ks = shift_k.shape[-1]
        k_pad = _pad(k, ((0, 0), (ks - 1, 0), (0, 0)))
        k_shift = torch.zeros_like(k)
        for t in range(ks):
            k_shift = k_shift + k_pad[:, t:t + S, :] * shift_k[:, ks - 1 - t][None, None, :]
        kv = k_shift * v
        L = 2 * S
        kv_pad = _pad(kv, ((0, 0), (0, S), (0, 0)))
        kf_pad = _pad(ssm_k, ((0, 0), (0, S)))
        kv_f = (lambda x, axes=(-2,-1): torch.fft.rfft2(x.float(), dim=axes))(kv_pad[:, None, :, :], axes=(1, 2))
        kf_f = (lambda x, axes=(-2,-1): torch.fft.rfft2(x.float(), dim=axes))(kf_pad[:, None, :], axes=(1, 2))
        kf_f = (lambda x, *d: x.permute(*d))(kf_f, 1, 2, 0)
        y_f = kv_f * kf_f[None, :, :, :]
        y = (lambda x, s, axes=(-2,-1): torch.fft.irfft2(x, s=s, dim=axes).to(torch.bfloat16))(y_f, (1, L), axes=(1, 2))[:, 0, :S, :]
        y = y + kv * ssm_D[None, None, :]
        return q * y

    def _B_ref(x, w_r, w_gate, w_up, w_down):
        B, S, D = x.shape
        C = 8
        r = x @ w_r
        idx = torch.argsort(-r, axis=-1)[:, :C]
        idx_e = (lambda x, n, axis: torch.repeat_interleave(x, n, dim=axis))(idx.reshape(B, C, 1), D, axis=2)
        x_sel = (lambda x, i, axis: torch.take_along_dim(x, i, dim=axis))(x, idx_e, axis=1)
        g = _silu(x_sel @ w_gate)
        u = x_sel @ w_up
        y = (g * u) @ w_down
        r_sel = _sigmoid((lambda x, i, axis: torch.take_along_dim(x, i, dim=axis))(r, idx, axis=1))
        y = y * r_sel.reshape(B, C, 1)
        b_off = (torch.arange(B) * S).reshape(B, 1)
        flat_idx = (idx + b_off).reshape(B * C)
        zero = (x * 0.0).reshape(B * S, D)
        upd = _scatter_add(zero, flat_idx, y.reshape(B * C, D), axis=0)
        return x + upd.reshape(B, S, D)

    x = A_q
    h = x + _A_ref(_layernorm(x, axis=-1), A_k, A_v, A_shift_k, A_ssm_k, A_ssm_D)
    h2 = h + _B_ref(_layernorm(h, axis=-1), B_w_r, B_w_gate, B_w_up, B_w_down)
    return h2
```

```asm
; @launch kernel=kvt_kernel grid=(320,1,1) block=(256,1,1) lds=9216
; @launch kernel=conv_kernel grid=(1055,1,1) block=(128,1,1) lds=16384
; @launch kernel=rows_kernel grid=(256,1,1) block=(512,1,1) lds=10240
; @launch kernel=ffn_kernel grid=(108,1,1) block=(256,1,1) lds=38144
.amdgcn_target "amdgcn-amd-amdhsa--gfx950"
.text
.globl kvt_kernel
.p2align 8
.type kvt_kernel,@function
kvt_kernel:
s_cmp_ge_u32 s2, 320
s_cbranch_scc1 K0_END
s_load_dwordx4 s[4:7], s[0:1], 8
s_load_dwordx2 s[8:9], s[0:1], 24
s_load_dwordx2 s[14:15], s[0:1], 104
s_mul_hi_u32 s16, s2, 0x1999999a
s_mul_i32 s17, s16, 10
s_sub_u32 s17, s2, s17
v_and_b32 v1, 7, v0
v_lshrrev_b32 v2, 3, v0
s_waitcnt lgkmcnt(0)
s_mov_b32 s40, s4
s_mov_b32 s41, s5
s_mov_b32 s42, 2621440
s_mov_b32 s43, 0x00020000
s_mov_b32 s44, s6
s_mov_b32 s45, s7
s_mov_b32 s46, 2621440
s_mov_b32 s47, 0x00020000
s_mov_b32 s48, s8
s_mov_b32 s49, s9
s_mov_b32 s50, 5120
s_mov_b32 s51, 0x00020000
s_add_u32 s52, s14, 7909376
s_addc_u32 s53, s15, 0
s_mov_b32 s54, 2621440
s_mov_b32 s55, 0x00020000
s_lshl_b32 s18, s17, 9
v_lshlrev_b32 v3, 6, v1
v_add_u32 v3, s18, v3
buffer_load_dwordx4 v[8:11], v3, s[48:51], 0 offen offset:0
buffer_load_dwordx4 v[12:15], v3, s[48:51], 0 offen offset:16
buffer_load_dwordx4 v[16:19], v3, s[48:51], 0 offen offset:32
buffer_load_dwordx4 v[20:23], v3, s[48:51], 0 offen offset:48
s_lshl_b32 s19, s16, 6
v_lshlrev_b32 v4, 1, v2
v_add_u32 v4, s19, v4
s_movk_i32 s20, 1280
v_mul_lo_u32 v4, v4, s20
s_lshl_b32 s21, s17, 7
v_lshlrev_b32 v5, 4, v1
v_add_u32 v4, v4, v5
v_add_u32 v4, s21, v4
v_subrev_u32 v5, 3840, v4
buffer_load_dwordx4 v[24:27], v5, s[40:43], 0 offen offset:0
buffer_load_dwordx4 v[28:31], v5, s[40:43], 0 offen offset:1280
buffer_load_dwordx4 v[32:35], v5, s[40:43], 0 offen offset:2560
buffer_load_dwordx4 v[36:39], v4, s[40:43], 0 offen offset:0
buffer_load_dwordx4 v[40:43], v4, s[40:43], 0 offen offset:1280
buffer_load_dwordx4 v[44:47], v4, s[44:47], 0 offen offset:0
buffer_load_dwordx4 v[48:51], v4, s[44:47], 0 offen offset:1280
s_movk_i32 s22, 1152
v_mul_lo_u32 v6, v1, s22
v_lshlrev_b32 v7, 2, v2
v_sub_u32 v7, 124, v7
v_add_u32 v6, v6, v7
s_waitcnt vmcnt(0)
v_lshlrev_b32 v64, 16, v24
v_and_b32 v69, 0xffff0000, v24
v_lshlrev_b32 v65, 16, v28
v_and_b32 v70, 0xffff0000, v28
v_lshlrev_b32 v66, 16, v32
v_and_b32 v71, 0xffff0000, v32
v_lshlrev_b32 v67, 16, v36
v_and_b32 v72, 0xffff0000, v36
v_lshlrev_b32 v68, 16, v40
v_and_b32 v73, 0xffff0000, v40
v_lshlrev_b32 v74, 16, v8
v_and_b32 v75, 0xffff0000, v8
v_lshlrev_b32 v76, 16, v9
v_and_b32 v77, 0xffff0000, v9
v_lshlrev_b32 v78, 16, v10
v_and_b32 v79, 0xffff0000, v10
v_lshlrev_b32 v80, 16, v11
v_and_b32 v81, 0xffff0000, v11
v_mul_f32 v82, v77, v64
v_mul_f32 v83, v77, v65
v_mul_f32 v84, v81, v69
v_mul_f32 v85, v81, v70
v_cvt_pk_bf16_f32 v90, v82, v83
v_cvt_pk_bf16_f32 v91, v84, v85
v_lshlrev_b32 v82, 16, v90
v_and_b32 v83, 0xffff0000, v90
v_lshlrev_b32 v84, 16, v91
v_and_b32 v85, 0xffff0000, v91
v_mul_f32 v86, v76, v65
v_mul_f32 v87, v76, v66
v_mul_f32 v88, v80, v70
v_mul_f32 v89, v80, v71
v_cvt_pk_bf16_f32 v90, v86, v87
v_cvt_pk_bf16_f32 v91, v88, v89
v_lshlrev_b32 v86, 16, v90
v_and_b32 v87, 0xffff0000, v90
v_lshlrev_b32 v88, 16, v91
v_and_b32 v89, 0xffff0000, v91
v_add_f32 v82, v82, v86
v_add_f32 v83, v83, v87
v_add_f32 v84, v84, v88
v_add_f32 v85, v85, v89
v_cvt_pk_bf16_f32 v90, v82, v83
v_cvt_pk_bf16_f32 v91, v84, v85
v_lshlrev_b32 v82, 16, v90
v_and_b32 v83, 0xffff0000, v90
v_lshlrev_b32 v84, 16, v91
v_and_b32 v85, 0xffff0000, v91
v_mul_f32 v86, v75, v66
v_mul_f32 v87, v75, v67
v_mul_f32 v88, v79, v71
v_mul_f32 v89, v79, v72
v_cvt_pk_bf16_f32 v90, v86, v87
v_cvt_pk_bf16_f32 v91, v88, v89
v_lshlrev_b32 v86, 16, v90
v_and_b32 v87, 0xffff0000, v90
v_lshlrev_b32 v88, 16, v91
v_and_b32 v89, 0xffff0000, v91
v_add_f32 v82, v82, v86
v_add_f32 v83, v83, v87
v_add_f32 v84, v84, v88
v_add_f32 v85, v85, v89
v_cvt_pk_bf16_f32 v90, v82, v83
v_cvt_pk_bf16_f32 v91, v84, v85
v_lshlrev_b32 v82, 16, v90
v_and_b32 v83, 0xffff0000, v90
v_lshlrev_b32 v84, 16, v91
v_and_b32 v85, 0xffff0000, v91
v_mul_f32 v86, v74, v67
v_mul_f32 v87, v74, v68
v_mul_f32 v88, v78, v72
v_mul_f32 v89, v78, v73
v_cvt_pk_bf16_f32 v90, v86, v87
v_cvt_pk_bf16_f32 v91, v88, v89
v_lshlrev_b32 v86, 16, v90
v_and_b32 v87, 0xffff0000, v90
v_lshlrev_b32 v88, 16, v91
v_and_b32 v89, 0xffff0000, v91
v_add_f32 v82, v82, v86
v_add_f32 v83, v83, v87
v_add_f32 v84, v84, v88
v_add_f32 v85, v85, v89
v_cvt_pk_bf16_f32 v90, v82, v83
v_cvt_pk_bf16_f32 v91, v84, v85
v_lshlrev_b32 v82, 16, v90
v_and_b32 v83, 0xffff0000, v90
v_lshlrev_b32 v84, 16, v91
v_and_b32 v85, 0xffff0000, v91
v_lshlrev_b32 v86, 16, v44
v_and_b32 v88, 0xffff0000, v44
v_lshlrev_b32 v87, 16, v48
v_and_b32 v89, 0xffff0000, v48
v_mul_f32 v82, v82, v86
v_mul_f32 v83, v83, v87
v_mul_f32 v84, v84, v88
v_mul_f32 v85, v85, v89
v_cvt_pk_bf16_f32 v90, v83, v82
ds_write_b32 v6, v90 offset:0
v_cvt_pk_bf16_f32 v91, v85, v84
ds_write_b32 v6, v91 offset:144
v_lshlrev_b32 v64, 16, v25
v_and_b32 v69, 0xffff0000, v25
v_lshlrev_b32 v65, 16, v29
v_and_b32 v70, 0xffff0000, v29
v_lshlrev_b32 v66, 16, v33
v_and_b32 v71, 0xffff0000, v33
v_lshlrev_b32 v67, 16, v37
v_and_b32 v72, 0xffff0000, v37
v_lshlrev_b32 v68, 16, v41
v_and_b32 v73, 0xffff0000, v41
v_lshlrev_b32 v74, 16, v12
v_and_b32 v75, 0xffff0000, v12
v_lshlrev_b32 v76, 16, v13
v_and_b32 v77, 0xffff0000, v13
v_lshlrev_b32 v78, 16, v14
v_and_b32 v79, 0xffff0000, v14
v_lshlrev_b32 v80, 16, v15
v_and_b32 v81, 0xffff0000, v15
v_mul_f32 v82, v77, v64
v_mul_f32 v83, v77, v65
v_mul_f32 v84, v81, v69
v_mul_f32 v85, v81, v70
v_cvt_pk_bf16_f32 v90, v82, v83
v_cvt_pk_bf16_f32 v91, v84, v85
v_lshlrev_b32 v82, 16, v90
v_and_b32 v83, 0xffff0000, v90
v_lshlrev_b32 v84, 16, v91
v_and_b32 v85, 0xffff0000, v91
v_mul_f32 v86, v76, v65
v_mul_f32 v87, v76, v66
v_mul_f32 v88, v80, v70
v_mul_f32 v89, v80, v71
v_cvt_pk_bf16_f32 v90, v86, v87
v_cvt_pk_bf16_f32 v91, v88, v89
v_lshlrev_b32 v86, 16, v90
v_and_b32 v87, 0xffff0000, v90
v_lshlrev_b32 v88, 16, v91
v_and_b32 v89, 0xffff0000, v91
v_add_f32 v82, v82, v86
v_add_f32 v83, v83, v87
v_add_f32 v84, v84, v88
v_add_f32 v85, v85, v89
v_cvt_pk_bf16_f32 v90, v82, v83
v_cvt_pk_bf16_f32 v91, v84, v85
v_lshlrev_b32 v82, 16, v90
v_and_b32 v83, 0xffff0000, v90
v_lshlrev_b32 v84, 16, v91
v_and_b32 v85, 0xffff0000, v91
v_mul_f32 v86, v75, v66
v_mul_f32 v87, v75, v67
v_mul_f32 v88, v79, v71
v_mul_f32 v89, v79, v72
v_cvt_pk_bf16_f32 v90, v86, v87
v_cvt_pk_bf16_f32 v91, v88, v89
v_lshlrev_b32 v86, 16, v90
v_and_b32 v87, 0xffff0000, v90
v_lshlrev_b32 v88, 16, v91
v_and_b32 v89, 0xffff0000, v91
v_add_f32 v82, v82, v86
v_add_f32 v83, v83, v87
v_add_f32 v84, v84, v88
v_add_f32 v85, v85, v89
v_cvt_pk_bf16_f32 v90, v82, v83
v_cvt_pk_bf16_f32 v91, v84, v85
v_lshlrev_b32 v82, 16, v90
v_and_b32 v83, 0xffff0000, v90
v_lshlrev_b32 v84, 16, v91
v_and_b32 v85, 0xffff0000, v91
v_mul_f32 v86, v74, v67
v_mul_f32 v87, v74, v68
v_mul_f32 v88, v78, v72
v_mul_f32 v89, v78, v73
v_cvt_pk_bf16_f32 v90, v86, v87
v_cvt_pk_bf16_f32 v91, v88, v89
v_lshlrev_b32 v86, 16, v90
v_and_b32 v87, 0xffff0000, v90
v_lshlrev_b32 v88, 16, v91
v_and_b32 v89, 0xffff0000, v91
v_add_f32 v82, v82, v86
v_add_f32 v83, v83, v87
v_add_f32 v84, v84, v88
v_add_f32 v85, v85, v89
v_cvt_pk_bf16_f32 v90, v82, v83
v_cvt_pk_bf16_f32 v91, v84, v85
v_lshlrev_b32 v82, 16, v90
v_and_b32 v83, 0xffff0000, v90
v_lshlrev_b32 v84, 16, v91
v_and_b32 v85, 0xffff0000, v91
v_lshlrev_b32 v86, 16, v45
v_and_b32 v88, 0xffff0000, v45
v_lshlrev_b32 v87, 16, v49
v_and_b32 v89, 0xffff0000, v49
v_mul_f32 v82, v82, v86
v_mul_f32 v83, v83, v87
v_mul_f32 v84, v84, v88
v_mul_f32 v85, v85, v89
v_cvt_pk_bf16_f32 v90, v83, v82
ds_write_b32 v6, v90 offset:288
v_cvt_pk_bf16_f32 v91, v85, v84
ds_write_b32 v6, v91 offset:432
v_lshlrev_b32 v64, 16, v26
v_and_b32 v69, 0xffff0000, v26
v_lshlrev_b32 v65, 16, v30
v_and_b32 v70, 0xffff0000, v30
v_lshlrev_b32 v66, 16, v34
v_and_b32 v71, 0xffff0000, v34
v_lshlrev_b32 v67, 16, v38
v_and_b32 v72, 0xffff0000, v38
v_lshlrev_b32 v68, 16, v42
v_and_b32 v73, 0xffff0000, v42
v_lshlrev_b32 v74, 16, v16
v_and_b32 v75, 0xffff0000, v16
v_lshlrev_b32 v76, 16, v17
v_and_b32 v77, 0xffff0000, v17
v_lshlrev_b32 v78, 16, v18
v_and_b32 v79, 0xffff0000, v18
v_lshlrev_b32 v80, 16, v19
v_and_b32 v81, 0xffff0000, v19
v_mul_f32 v82, v77, v64
v_mul_f32 v83, v77, v65
v_mul_f32 v84, v81, v69
v_mul_f32 v85, v81, v70
v_cvt_pk_bf16_f32 v90, v82, v83
v_cvt_pk_bf16_f32 v91, v84, v85
v_lshlrev_b32 v82, 16, v90
v_and_b32 v83, 0xffff0000, v90
v_lshlrev_b32 v84, 16, v91
v_and_b32 v85, 0xffff0000, v91
v_mul_f32 v86, v76, v65
v_mul_f32 v87, v76, v66
v_mul_f32 v88, v80, v70
v_mul_f32 v89, v80, v71
v_cvt_pk_bf16_f32 v90, v86, v87
v_cvt_pk_bf16_f32 v91, v88, v89
v_lshlrev_b32 v86, 16, v90
v_and_b32 v87, 0xffff0000, v90
v_lshlrev_b32 v88, 16, v91
v_and_b32 v89, 0xffff0000, v91
v_add_f32 v82, v82, v86
v_add_f32 v83, v83, v87
v_add_f32 v84, v84, v88
v_add_f32 v85, v85, v89
v_cvt_pk_bf16_f32 v90, v82, v83
v_cvt_pk_bf16_f32 v91, v84, v85
v_lshlrev_b32 v82, 16, v90
v_and_b32 v83, 0xffff0000, v90
v_lshlrev_b32 v84, 16, v91
v_and_b32 v85, 0xffff0000, v91
v_mul_f32 v86, v75, v66
v_mul_f32 v87, v75, v67
v_mul_f32 v88, v79, v71
v_mul_f32 v89, v79, v72
v_cvt_pk_bf16_f32 v90, v86, v87
v_cvt_pk_bf16_f32 v91, v88, v89
v_lshlrev_b32 v86, 16, v90
v_and_b32 v87, 0xffff0000, v90
v_lshlrev_b32 v88, 16, v91
v_and_b32 v89, 0xffff0000, v91
v_add_f32 v82, v82, v86
v_add_f32 v83, v83, v87
v_add_f32 v84, v84, v88
v_add_f32 v85, v85, v89
v_cvt_pk_bf16_f32 v90, v82, v83
v_cvt_pk_bf16_f32 v91, v84, v85
v_lshlrev_b32 v82, 16, v90
v_and_b32 v83, 0xffff0000, v90
v_lshlrev_b32 v84, 16, v91
v_and_b32 v85, 0xffff0000, v91
v_mul_f32 v86, v74, v67
v_mul_f32 v87, v74, v68
v_mul_f32 v88, v78, v72
v_mul_f32 v89, v78, v73
v_cvt_pk_bf16_f32 v90, v86, v87
v_cvt_pk_bf16_f32 v91, v88, v89
v_lshlrev_b32 v86, 16, v90
v_and_b32 v87, 0xffff0000, v90
v_lshlrev_b32 v88, 16, v91
v_and_b32 v89, 0xffff0000, v91
v_add_f32 v82, v82, v86
v_add_f32 v83, v83, v87
v_add_f32 v84, v84, v88
v_add_f32 v85, v85, v89
v_cvt_pk_bf16_f32 v90, v82, v83
v_cvt_pk_bf16_f32 v91, v84, v85
v_lshlrev_b32 v82, 16, v90
v_and_b32 v83, 0xffff0000, v90
v_lshlrev_b32 v84, 16, v91
v_and_b32 v85, 0xffff0000, v91
v_lshlrev_b32 v86, 16, v46
v_and_b32 v88, 0xffff0000, v46
v_lshlrev_b32 v87, 16, v50
v_and_b32 v89, 0xffff0000, v50
v_mul_f32 v82, v82, v86
v_mul_f32 v83, v83, v87
v_mul_f32 v84, v84, v88
v_mul_f32 v85, v85, v89
v_cvt_pk_bf16_f32 v90, v83, v82
ds_write_b32 v6, v90 offset:576
v_cvt_pk_bf16_f32 v91, v85, v84
ds_write_b32 v6, v91 offset:720
v_lshlrev_b32 v64, 16, v27
v_and_b32 v69, 0xffff0000, v27
v_lshlrev_b32 v65, 16, v31
v_and_b32 v70, 0xffff0000, v31
v_lshlrev_b32 v66, 16, v35
v_and_b32 v71, 0xffff0000, v35
v_lshlrev_b32 v67, 16, v39
v_and_b32 v72, 0xffff0000, v39
v_lshlrev_b32 v68, 16, v43
v_and_b32 v73, 0xffff0000, v43
v_lshlrev_b32 v74, 16, v20
v_and_b32 v75, 0xffff0000, v20
v_lshlrev_b32 v76, 16, v21
v_and_b32 v77, 0xffff0000, v21
v_lshlrev_b32 v78, 16, v22
v_and_b32 v79, 0xffff0000, v22
v_lshlrev_b32 v80, 16, v23
v_and_b32 v81, 0xffff0000, v23
v_mul_f32 v82, v77, v64
v_mul_f32 v83, v77, v65
v_mul_f32 v84, v81, v69
v_mul_f32 v85, v81, v70
v_cvt_pk_bf16_f32 v90, v82, v83
v_cvt_pk_bf16_f32 v91, v84, v85
v_lshlrev_b32 v82, 16, v90
v_and_b32 v83, 0xffff0000, v90
v_lshlrev_b32 v84, 16, v91
v_and_b32 v85, 0xffff0000, v91
v_mul_f32 v86, v76, v65
v_mul_f32 v87, v76, v66
v_mul_f32 v88, v80, v70
v_mul_f32 v89, v80, v71
v_cvt_pk_bf16_f32 v90, v86, v87
v_cvt_pk_bf16_f32 v91, v88, v89
v_lshlrev_b32 v86, 16, v90
v_and_b32 v87, 0xffff0000, v90
v_lshlrev_b32 v88, 16, v91
v_and_b32 v89, 0xffff0000, v91
v_add_f32 v82, v82, v86
v_add_f32 v83, v83, v87
v_add_f32 v84, v84, v88
v_add_f32 v85, v85, v89
v_cvt_pk_bf16_f32 v90, v82, v83
v_cvt_pk_bf16_f32 v91, v84, v85
v_lshlrev_b32 v82, 16, v90
v_and_b32 v83, 0xffff0000, v90
v_lshlrev_b32 v84, 16, v91
v_and_b32 v85, 0xffff0000, v91
v_mul_f32 v86, v75, v66
v_mul_f32 v87, v75, v67
v_mul_f32 v88, v79, v71
v_mul_f32 v89, v79, v72
v_cvt_pk_bf16_f32 v90, v86, v87
v_cvt_pk_bf16_f32 v91, v88, v89
v_lshlrev_b32 v86, 16, v90
v_and_b32 v87, 0xffff0000, v90
v_lshlrev_b32 v88, 16, v91
v_and_b32 v89, 0xffff0000, v91
v_add_f32 v82, v82, v86
v_add_f32 v83, v83, v87
v_add_f32 v84, v84, v88
v_add_f32 v85, v85, v89
v_cvt_pk_bf16_f32 v90, v82, v83
v_cvt_pk_bf16_f32 v91, v84, v85
v_lshlrev_b32 v82, 16, v90
v_and_b32 v83, 0xffff0000, v90
v_lshlrev_b32 v84, 16, v91
v_and_b32 v85, 0xffff0000, v91
v_mul_f32 v86, v74, v67
v_mul_f32 v87, v74, v68
v_mul_f32 v88, v78, v72
v_mul_f32 v89, v78, v73
v_cvt_pk_bf16_f32 v90, v86, v87
v_cvt_pk_bf16_f32 v91, v88, v89
v_lshlrev_b32 v86, 16, v90
v_and_b32 v87, 0xffff0000, v90
v_lshlrev_b32 v88, 16, v91
v_and_b32 v89, 0xffff0000, v91
v_add_f32 v82, v82, v86
v_add_f32 v83, v83, v87
v_add_f32 v84, v84, v88
v_add_f32 v85, v85, v89
v_cvt_pk_bf16_f32 v90, v82, v83
v_cvt_pk_bf16_f32 v91, v84, v85
v_lshlrev_b32 v82, 16, v90
v_and_b32 v83, 0xffff0000, v90
v_lshlrev_b32 v84, 16, v91
v_and_b32 v85, 0xffff0000, v91
v_lshlrev_b32 v86, 16, v47
v_and_b32 v88, 0xffff0000, v47
v_lshlrev_b32 v87, 16, v51
v_and_b32 v89, 0xffff0000, v51
v_mul_f32 v82, v82, v86
v_mul_f32 v83, v83, v87
v_mul_f32 v84, v84, v88
v_mul_f32 v85, v85, v89
v_cvt_pk_bf16_f32 v90, v83, v82
ds_write_b32 v6, v90 offset:864
v_cvt_pk_bf16_f32 v91, v85, v84
ds_write_b32 v6, v91 offset:1008
s_waitcnt lgkmcnt(0)
s_barrier
s_movk_i32 s22, 144
v_mul_lo_u32 v6, v2, s22
v_lshlrev_b32 v7, 4, v1
v_add_u32 v6, v6, v7
ds_read_b128 v[8:11], v6
ds_read_b128 v[12:15], v6 offset:4608
s_lshl_b32 s18, s17, 18
s_lshl_b32 s19, s16, 7
s_sub_u32 s19, 3968, s19
s_add_u32 s18, s18, s19
v_lshlrev_b32 v4, 12, v2
v_add_u32 v4, v4, v7
v_add_u32 v4, s18, v4
s_mov_b32 s23, 0x20000
s_waitcnt lgkmcnt(0)
buffer_store_dwordx4 v[8:11], v4, s[52:55], 0 offen
buffer_store_dwordx4 v[12:15], v4, s[52:55], s23 offen
K0_END:
s_endpgm
.globl conv_kernel
.p2align 8
.type conv_kernel,@function
conv_kernel:
s_cmp_ge_u32 s2, 1055
s_cbranch_scc1 K1_END
s_cmp_ge_u32 s2, 640
s_cbranch_scc1 K1_RELAY
s_load_dwordx2 s[10:11], s[0:1], 32
s_load_dwordx2 s[12:13], s[0:1], 40
s_load_dwordx2 s[14:15], s[0:1], 104
v_and_b32 v1, 63, v0
v_lshrrev_b32 v2, 6, v0
s_lshl_b32 s19, s2, 12
v_lshlrev_b32 v3, 4, v0
v_add_u32 v3, s19, v3
v_subrev_u32 v4, 4, v3
v_readfirstlane_b32 s18, v2
s_waitcnt lgkmcnt(0)
s_and_b32 s17, s2, 0xfffffffe
s_lshl_b32 s17, s17, 1
s_add_u32 s12, s12, s17
s_addc_u32 s13, s13, 0
s_load_dword s32, s[12:13], 0
s_mov_b32 s48, s10
s_mov_b32 s49, s11
s_mov_b32 s50, 2621440
s_mov_b32 s51, 0x00020000
s_add_u32 s44, s14, 7909376
s_addc_u32 s45, s15, 0
s_mov_b32 s46, 2621440
s_mov_b32 s47, 0x00020000
s_mov_b32 s52, s14
s_mov_b32 s53, s15
s_mov_b32 s54, 2621440
s_mov_b32 s55, 0x00020000
buffer_load_dwordx4 v[20:23], v3, s[48:51], 0 offen offset:0
buffer_load_dwordx4 v[24:27], v3, s[48:51], 0 offen offset:2048
buffer_load_dword v28, v4, s[48:51], 0 offen offset:0
buffer_load_dword v29, v4, s[48:51], 0 offen offset:2048
buffer_load_dwordx4 v[32:35], v3, s[44:47], 0 offen offset:0
buffer_load_dwordx4 v[36:39], v3, s[44:47], 0 offen offset:2048
v_mov_b32 v8, 0
v_mov_b32 v9, 0
v_mov_b32 v10, 0
v_mov_b32 v11, 0
v_lshlrev_b32 v12, 4, v0
v_cmp_gt_u32 vcc, 30, v0
s_and_saveexec_b64 s[38:39], vcc
ds_write_b128 v12, v[8:11] offset:12384
s_mov_b64 exec, s[38:39]
v_lshlrev_b32 v13, 2, v0
v_cmp_gt_u32 vcc, 8, v0
s_and_saveexec_b64 s[38:39], vcc
ds_write_b32 v13, v8 offset:0
s_mov_b64 exec, s[38:39]
v_cmp_gt_u32 vcc, 7, v0
s_and_saveexec_b64 s[38:39], vcc
ds_write_b32 v13, v8 offset:4164
s_mov_b64 exec, s[38:39]
v_and_b32 v2, 15, v1
v_lshrrev_b32 v3, 4, v1
v_lshlrev_b32 v4, 3, v3
v_add_u32 v4, v4, v2
v_lshlrev_b32 v4, 1, v4
v_and_b32 v5, 1, v2
v_cmp_eq_u32 vcc, 1, v5
v_mov_b32 v6, 4164
v_mov_b32 v7, 2
v_cndmask_b32 v5, v6, v7, vcc
s_lshl_b32 s20, s18, 8
v_add_u32 v40, v4, v5
v_add_u32 v40, s20, v40
v_add_u32 v41, 1024, v40
v_add_u32 v42, 2048, v40
v_add_u32 v43, 3072, v40
v_lshlrev_b32 v44, 5, v2
v_lshlrev_b32 v13, 4, v3
v_sub_u32 v44, 8768, v44
v_add_u32 v44, v44, v13
v_add_u32 v44, s20, v44
v_mov_b32 v128, 0
v_mov_b32 v129, 0
v_mov_b32 v130, 0
v_mov_b32 v131, 0
v_mov_b32 v132, 0
v_mov_b32 v133, 0
v_mov_b32 v134, 0
v_mov_b32 v135, 0
v_mov_b32 v136, 0
v_mov_b32 v137, 0
v_mov_b32 v138, 0
v_mov_b32 v139, 0
v_mov_b32 v140, 0
v_mov_b32 v141, 0
v_mov_b32 v142, 0
v_mov_b32 v143, 0
v_mov_b32 v144, 0
v_mov_b32 v145, 0
v_mov_b32 v146, 0
v_mov_b32 v147, 0
v_mov_b32 v148, 0
v_mov_b32 v149, 0
v_mov_b32 v150, 0
v_mov_b32 v151, 0
v_mov_b32 v152, 0
v_mov_b32 v153, 0
v_mov_b32 v154, 0
v_mov_b32 v155, 0
v_mov_b32 v156, 0
v_mov_b32 v157, 0
v_mov_b32 v158, 0
v_mov_b32 v159, 0
s_waitcnt vmcnt(2)
v_cmp_eq_u32 vcc, 0, v0
s_nop 1
v_cndmask_b32 v28, v28, v8, vcc
ds_write_b128 v12, v[20:23] offset:32
v_alignbit_b32 v16, v20, v28, 16
v_alignbit_b32 v17, v21, v20, 16
v_alignbit_b32 v18, v22, v21, 16
v_alignbit_b32 v19, v23, v22, 16
ds_write_b128 v12, v[16:19] offset:4192
s_nop 1
ds_write_b128 v12, v[24:27] offset:2080
v_alignbit_b32 v16, v24, v29, 16
v_alignbit_b32 v17, v25, v24, 16
v_alignbit_b32 v18, v26, v25, 16
v_alignbit_b32 v19, v27, v26, 16
ds_write_b128 v12, v[16:19] offset:6240
s_nop 1
s_waitcnt vmcnt(0)
ds_write_b128 v12, v[32:35] offset:8288
ds_write_b128 v12, v[36:39] offset:10336
s_waitcnt lgkmcnt(0)
s_and_b32 s35, s2, 1
s_cmp_eq_u32 s35, 0
s_cbranch_scc1 K1_DLO
s_and_b32 s34, s32, 0xffff0000
s_branch K1_DDONE
K1_DLO:
s_lshl_b32 s34, s32, 16
K1_DDONE:
s_barrier
ds_read2_b32 v[64:65], v40 offset0:0 offset1:1
ds_read2_b32 v[66:67], v40 offset0:2 offset1:3
ds_read2_b32 v[68:69], v40 offset0:128 offset1:129
ds_read2_b32 v[70:71], v40 offset0:130 offset1:131
ds_read2_b32 v[72:73], v41 offset0:0 offset1:1
ds_read2_b32 v[74:75], v41 offset0:2 offset1:3
ds_read2_b32 v[76:77], v41 offset0:128 offset1:129
ds_read2_b32 v[78:79], v41 offset0:130 offset1:131
ds_read2_b32 v[80:81], v42 offset0:0 offset1:1
ds_read2_b32 v[82:83], v42 offset0:2 offset1:3
ds_read2_b32 v[84:85], v42 offset0:128 offset1:129
ds_read2_b32 v[86:87], v42 offset0:130 offset1:131
ds_read2_b32 v[88:89], v43 offset0:0 offset1:1
ds_read2_b32 v[90:91], v43 offset0:2 offset1:3
ds_read2_b32 v[92:93], v43 offset0:128 offset1:129
ds_read2_b32 v[94:95], v43 offset0:130 offset1:131
ds_read_b128 v[96:99], v44 offset:3584
ds_read_b128 v[100:103], v44 offset:3072
ds_read_b128 v[104:107], v44 offset:2560
ds_read_b128 v[108:111], v44 offset:2048
ds_read_b128 v[112:115], v44 offset:1536
ds_read_b128 v[116:119], v44 offset:1024
ds_read_b128 v[120:123], v44 offset:512
ds_read_b128 v[124:127], v44 offset:0
s_waitcnt lgkmcnt(0)
v_mfma_f32_16x16x32_bf16 v[128:131], v[64:67], v[96:99], v[128:131]
ds_read2_b32 v[160:161], v40 offset0:16 offset1:17
ds_read2_b32 v[162:163], v40 offset0:18 offset1:19
v_mfma_f32_16x16x32_bf16 v[132:135], v[64:67], v[100:103], v[132:135]
ds_read2_b32 v[164:165], v40 offset0:144 offset1:145
ds_read2_b32 v[166:167], v40 offset0:146 offset1:147
v_mfma_f32_16x16x32_bf16 v[132:135], v[68:71], v[96:99], v[132:135]
ds_read2_b32 v[168:169], v41 offset0:16 offset1:17
ds_read2_b32 v[170:171], v41 offset0:18 offset1:19
v_mfma_f32_16x16x32_bf16 v[136:139], v[64:67], v[104:107], v[136:139]
ds_read2_b32 v[172:173], v41 offset0:144 offset1:145
ds_read2_b32 v[174:175], v41 offset0:146 offset1:147
v_mfma_f32_16x16x32_bf16 v[136:139], v[68:71], v[100:103], v[136:139]
ds_read2_b32 v[176:177], v42 offset0:16 offset1:17
ds_read2_b32 v[178:179], v42 offset0:18 offset1:19
v_mfma_f32_16x16x32_bf16 v[136:139], v[72:75], v[96:99], v[136:139]
ds_read2_b32 v[180:181], v42 offset0:144 offset1:145
ds_read2_b32 v[182:183], v42 offset0:146 offset1:147
v_mfma_f32_16x16x32_bf16 v[140:143], v[64:67], v[108:111], v[140:143]
ds_read2_b32 v[184:185], v43 offset0:16 offset1:17
ds_read2_b32 v[186:187], v43 offset0:18 offset1:19
v_mfma_f32_16x16x32_bf16 v[140:143], v[68:71], v[104:107], v[140:143]
ds_read2_b32 v[188:189], v43 offset0:144 offset1:145
ds_read2_b32 v[190:191], v43 offset0:146 offset1:147
v_mfma_f32_16x16x32_bf16 v[140:143], v[72:75], v[100:103], v[140:143]
ds_read_b128 v[192:195], v44 offset:3648
ds_read_b128 v[196:199], v44 offset:3136
v_mfma_f32_16x16x32_bf16 v[140:143], v[76:79], v[96:99], v[140:143]
ds_read_b128 v[200:203], v44 offset:2624
ds_read_b128 v[204:207], v44 offset:2112
v_mfma_f32_16x16x32_bf16 v[144:147], v[64:67], v[112:115], v[144:147]
ds_read_b128 v[208:211], v44 offset:1600
ds_read_b128 v[212:215], v44 offset:1088
v_mfma_f32_16x16x32_bf16 v[144:147], v[68:71], v[108:111], v[144:147]
ds_read_b128 v[216:219], v44 offset:576
ds_read_b128 v[220:223], v44 offset:64
v_mfma_f32_16x16x32_bf16 v[144:147], v[72:75], v[104:107], v[144:147]
v_mfma_f32_16x16x32_bf16 v[144:147], v[76:79], v[100:103], v[144:147]
v_mfma_f32_16x16x32_bf16 v[144:147], v[80:83], v[96:99], v[144:147]
v_mfma_f32_16x16x32_bf16 v[148:151], v[64:67], v[116:119], v[148:151]
v_mfma_f32_16x16x32_bf16 v[148:151], v[68:71], v[112:115], v[148:151]
v_mfma_f32_16x16x32_bf16 v[148:151], v[72:75], v[108:111], v[148:151]
v_mfma_f32_16x16x32_bf16 v[148:151], v[76:79], v[104:107], v[148:151]
v_mfma_f32_16x16x32_bf16 v[148:151], v[80:83], v[100:103], v[148:151]
v_mfma_f32_16x16x32_bf16 v[148:151], v[84:87], v[96:99], v[148:151]
v_mfma_f32_16x16x32_bf16 v[152:155], v[64:67], v[120:123], v[152:155]
v_mfma_f32_16x16x32_bf16 v[152:155], v[68:71], v[116:119], v[152:155]
v_mfma_f32_16x16x32_bf16 v[152:155], v[72:75], v[112:115], v[152:155]
v_mfma_f32_16x16x32_bf16 v[152:155], v[76:79], v[108:111], v[152:155]
v_mfma_f32_16x16x32_bf16 v[152:155], v[80:83], v[104:107], v[152:155]
v_mfma_f32_16x16x32_bf16 v[152:155], v[84:87], v[100:103], v[152:155]
v_mfma_f32_16x16x32_bf16 v[152:155], v[88:91], v[96:99], v[152:155]
v_mfma_f32_16x16x32_bf16 v[156:159], v[64:67], v[124:127], v[156:159]
v_mfma_f32_16x16x32_bf16 v[156:159], v[68:71], v[120:123], v[156:159]
v_mfma_f32_16x16x32_bf16 v[156:159], v[72:75], v[116:119], v[156:159]
v_mfma_f32_16x16x32_bf16 v[156:159], v[76:79], v[112:115], v[156:159]
v_mfma_f32_16x16x32_bf16 v[156:159], v[80:83], v[108:111], v[156:159]
v_mfma_f32_16x16x32_bf16 v[156:159], v[84:87], v[104:107], v[156:159]
v_mfma_f32_16x16x32_bf16 v[156:159], v[88:91], v[100:103], v[156:159]
v_mfma_f32_16x16x32_bf16 v[156:159], v[92:95], v[96:99], v[156:159]
s_waitcnt lgkmcnt(0)
v_mfma_f32_16x16x32_bf16 v[128:131], v[160:163], v[192:195], v[128:131]
ds_read2_b32 v[64:65], v40 offset0:32 offset1:33
ds_read2_b32 v[66:67], v40 offset0:34 offset1:35
v_mfma_f32_16x16x32_bf16 v[132:135], v[160:163], v[196:199], v[132:135]
ds_read2_b32 v[68:69], v40 offset0:160 offset1:161
ds_read2_b32 v[70:71], v40 offset0:162 offset1:163
v_mfma_f32_16x16x32_bf16 v[132:135], v[164:167], v[192:195], v[132:135]
ds_read2_b32 v[72:73], v41 offset0:32 offset1:33
ds_read2_b32 v[74:75], v41 offset0:34 offset1:35
v_mfma_f32_16x16x32_bf16 v[136:139], v[160:163], v[200:203], v[136:139]
ds_read2_b32 v[76:77], v41 offset0:160 offset1:161
ds_read2_b32 v[78:79], v41 offset0:162 offset1:163
v_mfma_f32_16x16x32_bf16 v[136:139], v[164:167], v[196:199], v[136:139]
ds_read2_b32 v[80:81], v42 offset0:32 offset1:33
ds_read2_b32 v[82:83], v42 offset0:34 offset1:35
v_mfma_f32_16x16x32_bf16 v[136:139], v[168:171], v[192:195], v[136:139]
ds_read2_b32 v[84:85], v42 offset0:160 offset1:161
ds_read2_b32 v[86:87], v42 offset0:162 offset1:163
v_mfma_f32_16x16x32_bf16 v[140:143], v[160:163], v[204:207], v[140:143]
ds_read2_b32 v[88:89], v43 offset0:32 offset1:33
ds_read2_b32 v[90:91], v43 offset0:34 offset1:35
v_mfma_f32_16x16x32_bf16 v[140:143], v[164:167], v[200:203], v[140:143]
ds_read2_b32 v[92:93], v43 offset0:160 offset1:161
ds_read2_b32 v[94:95], v43 offset0:162 offset1:163
v_mfma_f32_16x16x32_bf16 v[140:143], v[168:171], v[196:199], v[140:143]
ds_read_b128 v[96:99], v44 offset:3712
ds_read_b128 v[100:103], v44 offset:3200
v_mfma_f32_16x16x32_bf16 v[140:143], v[172:175], v[192:195], v[140:143]
ds_read_b128 v[104:107], v44 offset:2688
ds_read_b128 v[108:111], v44 offset:2176
v_mfma_f32_16x16x32_bf16 v[144:147], v[160:163], v[208:211], v[144:147]
ds_read_b128 v[112:115], v44 offset:1664
ds_read_b128 v[116:119], v44 offset:1152
v_mfma_f32_16x16x32_bf16 v[144:147], v[164:167], v[204:207], v[144:147]
ds_read_b128 v[120:123], v44 offset:640
ds_read_b128 v[124:127], v44 offset:128
v_mfma_f32_16x16x32_bf16 v[144:147], v[168:171], v[200:203], v[144:147]
v_mfma_f32_16x16x32_bf16 v[144:147], v[172:175], v[196:199], v[144:147]
v_mfma_f32_16x16x32_bf16 v[144:147], v[176:179], v[192:195], v[144:147]
v_mfma_f32_16x16x32_bf16 v[148:151], v[160:163], v[212:215], v[148:151]
v_mfma_f32_16x16x32_bf16 v[148:151], v[164:167], v[208:211], v[148:151]
v_mfma_f32_16x16x32_bf16 v[148:151], v[168:171], v[204:207], v[148:151]
v_mfma_f32_16x16x32_bf16 v[148:151], v[172:175], v[200:203], v[148:151]
v_mfma_f32_16x16x32_bf16 v[148:151], v[176:179], v[196:199], v[148:151]
v_mfma_f32_16x16x32_bf16 v[148:151], v[180:183], v[192:195], v[148:151]
v_mfma_f32_16x16x32_bf16 v[152:155], v[160:163], v[216:219], v[152:155]
v_mfma_f32_16x16x32_bf16 v[152:155], v[164:167], v[212:215], v[152:155]
v_mfma_f32_16x16x32_bf16 v[152:155], v[168:171], v[208:211], v[152:155]
v_mfma_f32_16x16x32_bf16 v[152:155], v[172:175], v[204:207], v[152:155]
v_mfma_f32_16x16x32_bf16 v[152:155], v[176:179], v[200:203], v[152:155]
v_mfma_f32_16x16x32_bf16 v[152:155], v[180:183], v[196:199], v[152:155]
v_mfma_f32_16x16x32_bf16 v[152:155], v[184:187], v[192:195], v[152:155]
v_mfma_f32_16x16x32_bf16 v[156:159], v[160:163], v[220:223], v[156:159]
v_mfma_f32_16x16x32_bf16 v[156:159], v[164:167], v[216:219], v[156:159]
v_mfma_f32_16x16x32_bf16 v[156:159], v[168:171], v[212:215], v[156:159]
v_mfma_f32_16x16x32_bf16 v[156:159], v[172:175], v[208:211], v[156:159]
v_mfma_f32_16x16x32_bf16 v[156:159], v[176:179], v[204:207], v[156:159]
v_mfma_f32_16x16x32_bf16 v[156:159], v[180:183], v[200:203], v[156:159]
v_mfma_f32_16x16x32_bf16 v[156:159], v[184:187], v[196:199], v[156:159]
v_mfma_f32_16x16x32_bf16 v[156:159], v[188:191], v[192:195], v[156:159]
s_waitcnt lgkmcnt(0)
v_mfma_f32_16x16x32_bf16 v[128:131], v[64:67], v[96:99], v[128:131]
ds_read2_b32 v[160:161], v40 offset0:48 offset1:49
ds_read2_b32 v[162:163], v40 offset0:50 offset1:51
v_mfma_f32_16x16x32_bf16 v[132:135], v[64:67], v[100:103], v[132:135]
ds_read2_b32 v[164:165], v40 offset0:176 offset1:177
ds_read2_b32 v[166:167], v40 offset0:178 offset1:179
v_mfma_f32_16x16x32_bf16 v[132:135], v[68:71], v[96:99], v[132:135]
ds_read2_b32 v[168:169], v41 offset0:48 offset1:49
ds_read2_b32 v[170:171], v41 offset0:50 offset1:51
v_mfma_f32_16x16x32_bf16 v[136:139], v[64:67], v[104:107], v[136:139]
ds_read2_b32 v[172:173], v41 offset0:176 offset1:177
ds_read2_b32 v[174:175], v41 offset0:178 offset1:179
v_mfma_f32_16x16x32_bf16 v[136:139], v[68:71], v[100:103], v[136:139]
ds_read2_b32 v[176:177], v42 offset0:48 offset1:49
ds_read2_b32 v[178:179], v42 offset0:50 offset1:51
v_mfma_f32_16x16x32_bf16 v[136:139], v[72:75], v[96:99], v[136:139]
ds_read2_b32 v[180:181], v42 offset0:176 offset1:177
ds_read2_b32 v[182:183], v42 offset0:178 offset1:179
v_mfma_f32_16x16x32_bf16 v[140:143], v[64:67], v[108:111], v[140:143]
ds_read2_b32 v[184:185], v43 offset0:48 offset1:49
ds_read2_b32 v[186:187], v43 offset0:50 offset1:51
v_mfma_f32_16x16x32_bf16 v[140:143], v[68:71], v[104:107], v[140:143]
ds_read2_b32 v[188:189], v43 offset0:176 offset1:177
ds_read2_b32 v[190:191], v43 offset0:178 offset1:179
v_mfma_f32_16x16x32_bf16 v[140:143], v[72:75], v[100:103], v[140:143]
ds_read_b128 v[192:195], v44 offset:3776
ds_read_b128 v[196:199], v44 offset:3264
v_mfma_f32_16x16x32_bf16 v[140:143], v[76:79], v[96:99], v[140:143]
ds_read_b128 v[200:203], v44 offset:2752
ds_read_b128 v[204:207], v44 offset:2240
v_mfma_f32_16x16x32_bf16 v[144:147], v[64:67], v[112:115], v[144:147]
ds_read_b128 v[208:211], v44 offset:1728
ds_read_b128 v[212:215], v44 offset:1216
v_mfma_f32_16x16x32_bf16 v[144:147], v[68:71], v[108:111], v[144:147]
ds_read_b128 v[216:219], v44 offset:704
ds_read_b128 v[220:223], v44 offset:192
v_mfma_f32_16x16x32_bf16 v[144:147], v[72:75], v[104:107], v[144:147]
v_mfma_f32_16x16x32_bf16 v[144:147], v[76:79], v[100:103], v[144:147]
v_mfma_f32_16x16x32_bf16 v[144:147], v[80:83], v[96:99], v[144:147]
v_mfma_f32_16x16x32_bf16 v[148:151], v[64:67], v[116:119], v[148:151]
v_mfma_f32_16x16x32_bf16 v[148:151], v[68:71], v[112:115], v[148:151]
v_mfma_f32_16x16x32_bf16 v[148:151], v[72:75], v[108:111], v[148:151]
v_mfma_f32_16x16x32_bf16 v[148:151], v[76:79], v[104:107], v[148:151]
v_mfma_f32_16x16x32_bf16 v[148:151], v[80:83], v[100:103], v[148:151]
v_mfma_f32_16x16x32_bf16 v[148:151], v[84:87], v[96:99], v[148:151]
v_mfma_f32_16x16x32_bf16 v[152:155], v[64:67], v[120:123], v[152:155]
v_mfma_f32_16x16x32_bf16 v[152:155], v[68:71], v[116:119], v[152:155]
v_mfma_f32_16x16x32_bf16 v[152:155], v[72:75], v[112:115], v[152:155]
v_mfma_f32_16x16x32_bf16 v[152:155], v[76:79], v[108:111], v[152:155]
v_mfma_f32_16x16x32_bf16 v[152:155], v[80:83], v[104:107], v[152:155]
v_mfma_f32_16x16x32_bf16 v[152:155], v[84:87], v[100:103], v[152:155]
v_mfma_f32_16x16x32_bf16 v[152:155], v[88:91], v[96:99], v[152:155]
v_mfma_f32_16x16x32_bf16 v[156:159], v[64:67], v[124:127], v[156:159]
v_mfma_f32_16x16x32_bf16 v[156:159], v[68:71], v[120:123], v[156:159]
v_mfma_f32_16x16x32_bf16 v[156:159], v[72:75], v[116:119], v[156:159]
v_mfma_f32_16x16x32_bf16 v[156:159], v[76:79], v[112:115], v[156:159]
v_mfma_f32_16x16x32_bf16 v[156:159], v[80:83], v[108:111], v[156:159]
v_mfma_f32_16x16x32_bf16 v[156:159], v[84:87], v[104:107], v[156:159]
v_mfma_f32_16x16x32_bf16 v[156:159], v[88:91], v[100:103], v[156:159]
v_mfma_f32_16x16x32_bf16 v[156:159], v[92:95], v[96:99], v[156:159]
s_waitcnt lgkmcnt(0)
v_mfma_f32_16x16x32_bf16 v[128:131], v[160:163], v[192:195], v[128:131]
v_mfma_f32_16x16x32_bf16 v[132:135], v[160:163], v[196:199], v[132:135]
v_mfma_f32_16x16x32_bf16 v[132:135], v[164:167], v[192:195], v[132:135]
v_mfma_f32_16x16x32_bf16 v[136:139], v[160:163], v[200:203], v[136:139]
v_mfma_f32_16x16x32_bf16 v[136:139], v[164:167], v[196:199], v[136:139]
v_mfma_f32_16x16x32_bf16 v[136:139], v[168:171], v[192:195], v[136:139]
v_mfma_f32_16x16x32_bf16 v[140:143], v[160:163], v[204:207], v[140:143]
v_mfma_f32_16x16x32_bf16 v[140:143], v[164:167], v[200:203], v[140:143]
v_mfma_f32_16x16x32_bf16 v[140:143], v[168:171], v[196:199], v[140:143]
v_mfma_f32_16x16x32_bf16 v[140:143], v[172:175], v[192:195], v[140:143]
v_mfma_f32_16x16x32_bf16 v[144:147], v[160:163], v[208:211], v[144:147]
v_mfma_f32_16x16x32_bf16 v[144:147], v[164:167], v[204:207], v[144:147]
v_mfma_f32_16x16x32_bf16 v[144:147], v[168:171], v[200:203], v[144:147]
v_mfma_f32_16x16x32_bf16 v[144:147], v[172:175], v[196:199], v[144:147]
v_mfma_f32_16x16x32_bf16 v[144:147], v[176:179], v[192:195], v[144:147]
v_mfma_f32_16x16x32_bf16 v[148:151], v[160:163], v[212:215], v[148:151]
v_mfma_f32_16x16x32_bf16 v[148:151], v[164:167], v[208:211], v[148:151]
v_mfma_f32_16x16x32_bf16 v[148:151], v[168:171], v[204:207], v[148:151]
v_mfma_f32_16x16x32_bf16 v[148:151], v[172:175], v[200:203], v[148:151]
v_mfma_f32_16x16x32_bf16 v[148:151], v[176:179], v[196:199], v[148:151]
v_mfma_f32_16x16x32_bf16 v[148:151], v[180:183], v[192:195], v[148:151]
v_mfma_f32_16x16x32_bf16 v[152:155], v[160:163], v[216:219], v[152:155]
v_mfma_f32_16x16x32_bf16 v[152:155], v[164:167], v[212:215], v[152:155]
v_mfma_f32_16x16x32_bf16 v[152:155], v[168:171], v[208:211], v[152:155]
v_mfma_f32_16x16x32_bf16 v[152:155], v[172:175], v[204:207], v[152:155]
v_mfma_f32_16x16x32_bf16 v[152:155], v[176:179], v[200:203], v[152:155]
v_mfma_f32_16x16x32_bf16 v[152:155], v[180:183], v[196:199], v[152:155]
v_mfma_f32_16x16x32_bf16 v[152:155], v[184:187], v[192:195], v[152:155]
v_mfma_f32_16x16x32_bf16 v[156:159], v[160:163], v[220:223], v[156:159]
v_mfma_f32_16x16x32_bf16 v[156:159], v[164:167], v[216:219], v[156:159]
v_mfma_f32_16x16x32_bf16 v[156:159], v[168:171], v[212:215], v[156:159]
v_mfma_f32_16x16x32_bf16 v[156:159], v[172:175], v[208:211], v[156:159]
v_mfma_f32_16x16x32_bf16 v[156:159], v[176:179], v[204:207], v[156:159]
v_mfma_f32_16x16x32_bf16 v[156:159], v[180:183], v[200:203], v[156:159]
v_mfma_f32_16x16x32_bf16 v[156:159], v[184:187], v[196:199], v[156:159]
v_mfma_f32_16x16x32_bf16 v[156:159], v[188:191], v[192:195], v[156:159]
s_nop 15
s_barrier
v_lshlrev_b32 v5, 2, v1
s_xor_b32 s21, s18, 1
s_lshl_b32 s21, s21, 12
v_add_u32 v6, s21, v5
s_lshl_b32 s22, s18, 12
v_add_u32 v7, s22, v5
s_cmp_eq_u32 s18, 0
s_cbranch_scc1 K1_W0
ds_write_b32 v6, v128 offset:0
ds_write_b32 v6, v129 offset:256
ds_write_b32 v6, v130 offset:512
ds_write_b32 v6, v131 offset:768
ds_write_b32 v6, v132 offset:1024
ds_write_b32 v6, v133 offset:1280
ds_write_b32 v6, v134 offset:1536
ds_write_b32 v6, v135 offset:1792
ds_write_b32 v6, v136 offset:2048
ds_write_b32 v6, v137 offset:2304
ds_write_b32 v6, v138 offset:2560
ds_write_b32 v6, v139 offset:2816
ds_write_b32 v6, v140 offset:3072
ds_write_b32 v6, v141 offset:3328
ds_write_b32 v6, v142 offset:3584
ds_write_b32 v6, v143 offset:3840
v_mov_b32 v128, v144
v_mov_b32 v129, v145
v_mov_b32 v130, v146
v_mov_b32 v131, v147
v_mov_b32 v132, v148
v_mov_b32 v133, v149
v_mov_b32 v134, v150
v_mov_b32 v135, v151
v_mov_b32 v136, v152
v_mov_b32 v137, v153
v_mov_b32 v138, v154
v_mov_b32 v139, v155
v_mov_b32 v140, v156
v_mov_b32 v141, v157
v_mov_b32 v142, v158
v_mov_b32 v143, v159
s_branch K1_XDONE
K1_W0:
ds_write_b32 v6, v144 offset:0
ds_write_b32 v6, v145 offset:256
ds_write_b32 v6, v146 offset:512
ds_write_b32 v6, v147 offset:768
ds_write_b32 v6, v148 offset:1024
ds_write_b32 v6, v149 offset:1280
ds_write_b32 v6, v150 offset:1536
ds_write_b32 v6, v151 offset:1792
ds_write_b32 v6, v152 offset:2048
ds_write_b32 v6, v153 offset:2304
ds_write_b32 v6, v154 offset:2560
ds_write_b32 v6, v155 offset:2816
ds_write_b32 v6, v156 offset:3072
ds_write_b32 v6, v157 offset:3328
ds_write_b32 v6, v158 offset:3584
ds_write_b32 v6, v159 offset:3840
K1_XDONE:
s_waitcnt lgkmcnt(0)
s_barrier
ds_read_b32 v64, v7 offset:0
ds_read_b32 v65, v7 offset:256
ds_read_b32 v66, v7 offset:512
ds_read_b32 v67, v7 offset:768
ds_read_b32 v68, v7 offset:1024
ds_read_b32 v69, v7 offset:1280
ds_read_b32 v70, v7 offset:1536
ds_read_b32 v71, v7 offset:1792
ds_read_b32 v72, v7 offset:2048
ds_read_b32 v73, v7 offset:2304
ds_read_b32 v74, v7 offset:2560
ds_read_b32 v75, v7 offset:2816
ds_read_b32 v76, v7 offset:3072
ds_read_b32 v77, v7 offset:3328
ds_read_b32 v78, v7 offset:3584
ds_read_b32 v79, v7 offset:3840
v_lshlrev_b32 v4, 5, v2
v_lshlrev_b32 v5, 3, v3
v_add_u32 v4, v4, v5
s_lshl_b32 s23, s18, 11
v_sub_u32 v8, 10840, v4
v_subrev_u32 v8, s23, v8
ds_read_b64 v[80:81], v8 offset:1536
ds_read_b64 v[82:83], v8 offset:1024
ds_read_b64 v[84:85], v8 offset:512
ds_read_b64 v[86:87], v8 offset:0
v_add_u32 v9, s19, v4
v_add_u32 v9, s23, v9
s_waitcnt lgkmcnt(0)
v_add_f32 v128, v128, v64
v_add_f32 v129, v129, v65
v_add_f32 v130, v130, v66
v_add_f32 v131, v131, v67
v_cvt_pk_bf16_f32 v20, v128, v129
v_cvt_pk_bf16_f32 v21, v130, v131
v_lshlrev_b32 v128, 16, v20
v_and_b32 v129, 0xffff0000, v20
v_lshlrev_b32 v130, 16, v21
v_and_b32 v131, 0xffff0000, v21
v_and_b32 v24, 0xffff0000, v81
v_lshlrev_b32 v25, 16, v81
v_and_b32 v26, 0xffff0000, v80
v_lshlrev_b32 v27, 16, v80
v_mul_f32 v24, s34, v24
v_mul_f32 v25, s34, v25
v_mul_f32 v26, s34, v26
v_mul_f32 v27, s34, v27
v_cvt_pk_bf16_f32 v20, v24, v25
v_cvt_pk_bf16_f32 v21, v26, v27
v_lshlrev_b32 v24, 16, v20
v_and_b32 v25, 0xffff0000, v20
v_lshlrev_b32 v26, 16, v21
v_and_b32 v27, 0xffff0000, v21
v_add_f32 v24, v24, v128
v_add_f32 v25, v25, v129
v_add_f32 v26, v26, v130
v_add_f32 v27, v27, v131
v_cvt_pk_bf16_f32 v96, v24, v25
v_cvt_pk_bf16_f32 v97, v26, v27
buffer_store_dwordx2 v[96:97], v9, s[52:55], 0 offen offset:0
v_add_f32 v132, v132, v68
v_add_f32 v133, v133, v69
v_add_f32 v134, v134, v70
v_add_f32 v135, v135, v71
v_cvt_pk_bf16_f32 v20, v132, v133
v_cvt_pk_bf16_f32 v21, v134, v135
v_lshlrev_b32 v132, 16, v20
v_and_b32 v133, 0xffff0000, v20
v_lshlrev_b32 v134, 16, v21
v_and_b32 v135, 0xffff0000, v21
v_and_b32 v24, 0xffff0000, v83
v_lshlrev_b32 v25, 16, v83
v_and_b32 v26, 0xffff0000, v82
v_lshlrev_b32 v27, 16, v82
v_mul_f32 v24, s34, v24
v_mul_f32 v25, s34, v25
v_mul_f32 v26, s34, v26
v_mul_f32 v27, s34, v27
v_cvt_pk_bf16_f32 v20, v24, v25
v_cvt_pk_bf16_f32 v21, v26, v27
v_lshlrev_b32 v24, 16, v20
v_and_b32 v25, 0xffff0000, v20
v_lshlrev_b32 v26, 16, v21
v_and_b32 v27, 0xffff0000, v21
v_add_f32 v24, v24, v132
v_add_f32 v25, v25, v133
v_add_f32 v26, v26, v134
v_add_f32 v27, v27, v135
v_cvt_pk_bf16_f32 v98, v24, v25
v_cvt_pk_bf16_f32 v99, v26, v27
buffer_store_dwordx2 v[98:99], v9, s[52:55], 0 offen offset:512
v_add_f32 v136, v136, v72
v_add_f32 v137, v137, v73
v_add_f32 v138, v138, v74
v_add_f32 v139, v139, v75
v_cvt_pk_bf16_f32 v20, v136, v137
v_cvt_pk_bf16_f32 v21, v138, v139
v_lshlrev_b32 v136, 16, v20
v_and_b32 v137, 0xffff0000, v20
v_lshlrev_b32 v138, 16, v21
v_and_b32 v139, 0xffff0000, v21
v_and_b32 v24, 0xffff0000, v85
v_lshlrev_b32 v25, 16, v85
v_and_b32 v26, 0xffff0000, v84
v_lshlrev_b32 v27, 16, v84
v_mul_f32 v24, s34, v24
v_mul_f32 v25, s34, v25
v_mul_f32 v26, s34, v26
v_mul_f32 v27, s34, v27
v_cvt_pk_bf16_f32 v20, v24, v25
v_cvt_pk_bf16_f32 v21, v26, v27
v_lshlrev_b32 v24, 16, v20
v_and_b32 v25, 0xffff0000, v20
v_lshlrev_b32 v26, 16, v21
v_and_b32 v27, 0xffff0000, v21
v_add_f32 v24, v24, v136
v_add_f32 v25, v25, v137
v_add_f32 v26, v26, v138
v_add_f32 v27, v27, v139
v_cvt_pk_bf16_f32 v100, v24, v25
v_cvt_pk_bf16_f32 v101, v26, v27
buffer_store_dwordx2 v[100:101], v9, s[52:55], 0 offen offset:1024
v_add_f32 v140, v140, v76
v_add_f32 v141, v141, v77
v_add_f32 v142, v142, v78
v_add_f32 v143, v143, v79
v_cvt_pk_bf16_f32 v20, v140, v141
v_cvt_pk_bf16_f32 v21, v142, v143
v_lshlrev_b32 v140, 16, v20
v_and_b32 v141, 0xffff0000, v20
v_lshlrev_b32 v142, 16, v21
v_and_b32 v143, 0xffff0000, v21
v_and_b32 v24, 0xffff0000, v87
v_lshlrev_b32 v25, 16, v87
v_and_b32 v26, 0xffff0000, v86
v_lshlrev_b32 v27, 16, v86
v_mul_f32 v24, s34, v24
v_mul_f32 v25, s34, v25
v_mul_f32 v26, s34, v26
v_mul_f32 v27, s34, v27
v_cvt_pk_bf16_f32 v20, v24, v25
v_cvt_pk_bf16_f32 v21, v26, v27
v_lshlrev_b32 v24, 16, v20
v_and_b32 v25, 0xffff0000, v20
v_lshlrev_b32 v26, 16, v21
v_and_b32 v27, 0xffff0000, v21
v_add_f32 v24, v24, v140
v_add_f32 v25, v25, v141
v_add_f32 v26, v26, v142
v_add_f32 v27, v27, v143
v_cvt_pk_bf16_f32 v102, v24, v25
v_cvt_pk_bf16_f32 v103, v26, v27
buffer_store_dwordx2 v[102:103], v9, s[52:55], 0 offen offset:1536
s_endpgm
K1_RELAY:
s_load_dwordx4 s[4:7], s[0:1], 64
s_load_dwordx2 s[8:9], s[0:1], 80
s_load_dwordx2 s[14:15], s[0:1], 104
v_and_b32 v1, 63, v0
v_lshrrev_b32 v2, 6, v0
s_mov_b32 s30, 0x05040100
s_mov_b32 s31, 0x07060302
v_readfirstlane_b32 s18, v2
s_sub_u32 s16, s2, 640
s_lshl_b32 s16, s16, 1
s_nop 2
s_add_u32 s16, s16, s18
v_lshrrev_b32 v3, 3, v1
v_bfe_u32 v4, v1, 1, 2
v_and_b32 v5, 1, v1
s_cmp_ge_u32 s16, 560
s_cbranch_scc1 K1_RDOWN
s_cmp_ge_u32 s16, 280
s_cselect_b32 s17, 1, 0
s_mul_i32 s19, s17, 280
s_sub_u32 s16, s16, s19
s_mul_hi_u32 s20, s16, 306783379
s_mul_i32 s19, s20, 14
s_sub_u32 s21, s16, s19
s_waitcnt lgkmcnt(0)
s_cmp_eq_u32 s17, 0
s_cselect_b32 s4, s4, s6
s_cselect_b32 s5, s5, s7
s_mov_b32 s40, s4
s_mov_b32 s41, s5
s_mov_b32 s42, 2211840
s_mov_b32 s43, 0x00020000
s_add_u32 s44, s14, 10530816
s_addc_u32 s45, s15, 0
s_mov_b32 s46, 4423680
s_mov_b32 s47, 0x00020000
s_movk_i32 s22, 3456
s_movk_i32 s23, 108
s_mul_i32 s24, s17, 20
s_add_u32 s24, s24, s20
s_lshl_b32 s24, s24, 10
s_mov_b32 s25, 40960
s_branch K1_RGO
K1_RDOWN:
s_sub_u32 s16, s16, 560
s_mul_hi_u32 s20, s16, 858993460
s_mul_i32 s19, s20, 5
s_sub_u32 s21, s16, s19
s_waitcnt lgkmcnt(0)
s_mov_b32 s40, s8
s_mov_b32 s41, s9
s_mov_b32 s42, 2211840
s_mov_b32 s43, 0x00020000
s_add_u32 s44, s14, 14954496
s_addc_u32 s45, s15, 0
s_mov_b32 s46, 2211840
s_mov_b32 s47, 0x00020000
s_movk_i32 s22, 1280
s_movk_i32 s23, 40
s_lshl_b32 s24, s20, 10
s_mov_b32 s25, 55296
K1_RGO:
s_lshl_b32 s26, s20, 5
v_lshlrev_b32 v6, 3, v4
v_add_u32 v6, s26, v6
v_mul_lo_u32 v6, v6, s22
s_lshl_b32 s27, s21, 8
v_lshlrev_b32 v7, 5, v3
v_add_u32 v6, v6, v7
v_lshlrev_b32 v7, 4, v5
v_add_u32 v6, v6, v7
v_add_u32 v6, s27, v6
s_mov_b32 s28, 0
buffer_load_dwordx4 v[8:11], v6, s[40:43], s28 offen
s_add_u32 s28, s28, s22
buffer_load_dwordx4 v[12:15], v6, s[40:43], s28 offen
s_add_u32 s28, s28, s22
buffer_load_dwordx4 v[16:19], v6, s[40:43], s28 offen
s_add_u32 s28, s28, s22
buffer_load_dwordx4 v[20:23], v6, s[40:43], s28 offen
s_add_u32 s28, s28, s22
buffer_load_dwordx4 v[24:27], v6, s[40:43], s28 offen
s_add_u32 s28, s28, s22
buffer_load_dwordx4 v[28:31], v6, s[40:43], s28 offen
s_add_u32 s28, s28, s22
buffer_load_dwordx4 v[32:35], v6, s[40:43], s28 offen
s_add_u32 s28, s28, s22
buffer_load_dwordx4 v[36:39], v6, s[40:43], s28 offen
s_lshl_b32 s29, s18, 13
v_lshlrev_b32 v72, 7, v1
v_add_u32 v72, s29, v72
v_and_b32 v73, 7, v1
v_lshlrev_b32 v73, 4, v73
v_lshlrev_b32 v74, 7, v3
v_lshlrev_b32 v75, 4, v3
v_xor_b32 v75, v75, v73
v_add_u32 v74, v74, v75
v_add_u32 v74, s29, v74
s_waitcnt vmcnt(0)
v_perm_b32 v40, v12, v8, s30
v_perm_b32 v41, v20, v16, s30
v_perm_b32 v42, v28, v24, s30
v_perm_b32 v43, v36, v32, s30
v_perm_b32 v44, v12, v8, s31
v_perm_b32 v45, v20, v16, s31
v_perm_b32 v46, v28, v24, s31
v_perm_b32 v47, v36, v32, s31
v_perm_b32 v48, v13, v9, s30
v_perm_b32 v49, v21, v17, s30
v_perm_b32 v50, v29, v25, s30
v_perm_b32 v51, v37, v33, s30
v_perm_b32 v52, v13, v9, s31
v_perm_b32 v53, v21, v17, s31
v_perm_b32 v54, v29, v25, s31
v_perm_b32 v55, v37, v33, s31
v_perm_b32 v56, v14, v10, s30
v_perm_b32 v57, v22, v18, s30
v_perm_b32 v58, v30, v26, s30
v_perm_b32 v59, v38, v34, s30
v_perm_b32 v60, v14, v10, s31
v_perm_b32 v61, v22, v18, s31
v_perm_b32 v62, v30, v26, s31
v_perm_b32 v63, v38, v34, s31
v_perm_b32 v64, v15, v11, s30
v_perm_b32 v65, v23, v19, s30
v_perm_b32 v66, v31, v27, s30
v_perm_b32 v67, v39, v35, s30
v_perm_b32 v68, v15, v11, s31
v_perm_b32 v69, v23, v19, s31
v_perm_b32 v70, v31, v27, s31
v_perm_b32 v71, v39, v35, s31
v_xor_b32 v75, 0, v73
v_add_u32 v75, v72, v75
ds_write_b128 v75, v[40:43]
v_xor_b32 v75, 16, v73
v_add_u32 v75, v72, v75
ds_write_b128 v75, v[44:47]
v_xor_b32 v75, 32, v73
v_add_u32 v75, v72, v75
ds_write_b128 v75, v[48:51]
v_xor_b32 v75, 48, v73
v_add_u32 v75, v72, v75
ds_write_b128 v75, v[52:55]
v_xor_b32 v75, 64, v73
v_add_u32 v75, v72, v75
ds_write_b128 v75, v[56:59]
v_xor_b32 v75, 80, v73
v_add_u32 v75, v72, v75
ds_write_b128 v75, v[60:63]
v_xor_b32 v75, 96, v73
v_add_u32 v75, v72, v75
ds_write_b128 v75, v[64:67]
v_xor_b32 v75, 112, v73
v_add_u32 v75, v72, v75
ds_write_b128 v75, v[68:71]
s_waitcnt lgkmcnt(0)
ds_read_b128 v[8:11], v74 offset:0
ds_read_b128 v[12:15], v74 offset:1024
ds_read_b128 v[16:19], v74 offset:2048
ds_read_b128 v[20:23], v74 offset:3072
ds_read_b128 v[24:27], v74 offset:4096
ds_read_b128 v[28:31], v74 offset:5120
ds_read_b128 v[32:35], v74 offset:6144
ds_read_b128 v[36:39], v74 offset:7168
s_lshl_b32 s26, s21, 3
s_mul_i32 s27, s26, s25
s_add_u32 s27, s27, s24
v_lshlrev_b32 v6, 4, v1
s_waitcnt lgkmcnt(0)
s_cmp_ge_u32 s26, s23
s_cbranch_scc1 K1_END
buffer_store_dwordx4 v[8:11], v6, s[44:47], s27 offen
s_add_u32 s26, s26, 1
s_add_u32 s27, s27, s25
s_cmp_ge_u32 s26, s23
s_cbranch_scc1 K1_END
buffer_store_dwordx4 v[12:15], v6, s[44:47], s27 offen
s_add_u32 s26, s26, 1
s_add_u32 s27, s27, s25
s_cmp_ge_u32 s26, s23
s_cbranch_scc1 K1_END
buffer_store_dwordx4 v[16:19], v6, s[44:47], s27 offen
s_add_u32 s26, s26, 1
s_add_u32 s27, s27, s25
s_cmp_ge_u32 s26, s23
s_cbranch_scc1 K1_END
buffer_store_dwordx4 v[20:23], v6, s[44:47], s27 offen
s_add_u32 s26, s26, 1
s_add_u32 s27, s27, s25
s_cmp_ge_u32 s26, s23
s_cbranch_scc1 K1_END
buffer_store_dwordx4 v[24:27], v6, s[44:47], s27 offen
s_add_u32 s26, s26, 1
s_add_u32 s27, s27, s25
s_cmp_ge_u32 s26, s23
s_cbranch_scc1 K1_END
buffer_store_dwordx4 v[28:31], v6, s[44:47], s27 offen
s_add_u32 s26, s26, 1
s_add_u32 s27, s27, s25
s_cmp_ge_u32 s26, s23
s_cbranch_scc1 K1_END
buffer_store_dwordx4 v[32:35], v6, s[44:47], s27 offen
s_add_u32 s26, s26, 1
s_add_u32 s27, s27, s25
s_cmp_ge_u32 s26, s23
s_cbranch_scc1 K1_END
buffer_store_dwordx4 v[36:39], v6, s[44:47], s27 offen
s_add_u32 s26, s26, 1
s_add_u32 s27, s27, s25
K1_END:
s_endpgm
.globl rows_kernel
.p2align 8
.type rows_kernel,@function
rows_kernel:
s_cmp_ge_u32 s2, 256
s_cbranch_scc1 K2_END
s_load_dwordx2 s[4:5], s[0:1], 0
s_load_dwordx2 s[6:7], s[0:1], 56
s_load_dwordx2 s[8:9], s[0:1], 88
s_load_dwordx2 s[14:15], s[0:1], 104
s_and_b32 s16, s2, 7
s_lshl_b32 s16, s16, 5
s_lshr_b32 s17, s2, 3
s_add_u32 s16, s16, s17
v_and_b32 v1, 63, v0
v_lshrrev_b32 v2, 6, v0
s_lshl_b32 s18, s16, 3
v_add_u32 v2, s18, v2
s_movk_i32 s17, 1280
v_mul_lo_u32 v3, v2, s17
v_lshlrev_b32 v4, 4, v1
v_lshlrev_b32 v5, 2, v1
v_add_u32 v5, 1024, v5
v_add_u32 v6, v3, v4
v_add_u32 v7, v3, v5
v_lshlrev_b32 v30, 13, v0
s_lshl_b32 s19, s16, 4
v_add_u32 v30, s19, v30
s_mov_b32 s28, 0x05040100
s_mov_b32 s29, 0x07060302
s_waitcnt lgkmcnt(0)
s_mov_b32 s40, s4
s_mov_b32 s41, s5
s_mov_b32 s42, 2621440
s_mov_b32 s43, 0x00020000
s_mov_b32 s44, s6
s_mov_b32 s45, s7
s_mov_b32 s46, 1280
s_mov_b32 s47, 0x00020000
s_mov_b32 s48, s8
s_mov_b32 s49, s9
s_mov_b32 s50, 2621440
s_mov_b32 s51, 0x00020000
s_mov_b32 s52, s14
s_mov_b32 s53, s15
s_mov_b32 s54, 2621440
s_mov_b32 s55, 0x00020000
s_add_u32 s56, s14, 2621440
s_addc_u32 s57, s15, 0
s_mov_b32 s58, 2621440
s_mov_b32 s59, 0x00020000
s_add_u32 s60, s14, 5242880
s_addc_u32 s61, s15, 0
s_mov_b32 s62, 2621440
s_mov_b32 s63, 0x00020000
s_add_u32 s64, s14, 7864320
s_addc_u32 s65, s15, 0
s_mov_b32 s66, 8192
s_mov_b32 s67, 0x00020000
s_movk_i32 s20, 4096
buffer_load_dwordx4 v[32:35], v30, s[52:55], 0 offen
buffer_load_dwordx4 v[36:39], v30, s[52:55], s20 offen
buffer_load_dwordx4 v[8:11], v6, s[40:43], 0 offen
buffer_load_dword v12, v7, s[40:43], 0 offen
buffer_load_dwordx4 v[24:27], v4, s[44:47], 0 offen
buffer_load_dword v28, v5, s[44:47], 0 offen
v_lshlrev_b32 v31, 2, v0
s_waitcnt vmcnt(4)
v_cmp_gt_u32 vcc, 320, v0
s_and_saveexec_b64 s[30:31], vcc
v_perm_b32 v40, v36, v32, s28
v_perm_b32 v41, v36, v32, s29
v_perm_b32 v42, v37, v33, s28
v_perm_b32 v43, v37, v33, s29
v_perm_b32 v44, v38, v34, s28
v_perm_b32 v45, v38, v34, s29
v_perm_b32 v46, v39, v35, s28
v_perm_b32 v47, v39, v35, s29
ds_write_b32 v31, v40 offset:0
ds_write_b32 v31, v41 offset:1280
ds_write_b32 v31, v42 offset:2560
ds_write_b32 v31, v43 offset:3840
ds_write_b32 v31, v44 offset:5120
ds_write_b32 v31, v45 offset:6400
ds_write_b32 v31, v46 offset:7680
ds_write_b32 v31, v47 offset:8960
s_mov_b64 exec, s[30:31]
s_waitcnt vmcnt(2)
v_lshlrev_b32 v64, 16, v8
v_and_b32 v65, 0xffff0000, v8
v_lshlrev_b32 v66, 16, v9
v_and_b32 v67, 0xffff0000, v9
v_lshlrev_b32 v68, 16, v10
v_and_b32 v69, 0xffff0000, v10
v_lshlrev_b32 v70, 16, v11
v_and_b32 v71, 0xffff0000, v11
v_lshlrev_b32 v72, 16, v12
v_and_b32 v73, 0xffff0000, v12
s_waitcnt lgkmcnt(0)
s_barrier
v_lshrrev_b32 v29, 6, v0
v_mul_lo_u32 v29, v29, s17
v_add_u32 v31, v29, v4
v_add_u32 v29, v29, v5
ds_read_b128 v[16:19], v31
ds_read_b32 v20, v29
v_add_f32 v60, v64, v65
v_add_f32 v60, v60, v66
v_add_f32 v60, v60, v67
v_add_f32 v60, v60, v68
v_add_f32 v60, v60, v69
v_add_f32 v60, v60, v70
v_add_f32 v60, v60, v71
v_add_f32 v60, v60, v72
v_add_f32 v60, v60, v73
s_nop 1
v_add_f32_dpp v60, v60, v60 quad_perm:[1,0,3,2] row_mask:0xf bank_mask:0xf
s_nop 1
v_add_f32_dpp v60, v60, v60 quad_perm:[2,3,0,1] row_mask:0xf bank_mask:0xf
s_nop 1
v_add_f32_dpp v60, v60, v60 row_half_mirror row_mask:0xf bank_mask:0xf
s_nop 1
v_add_f32_dpp v60, v60, v60 row_mirror row_mask:0xf bank_mask:0xf
s_nop 1
v_add_f32_dpp v60, v60, v60 row_bcast:15 row_mask:0xa bank_mask:0xf
s_nop 1
v_add_f32_dpp v60, v60, v60 row_bcast:31 row_mask:0xc bank_mask:0xf
s_nop 1
v_readlane_b32 s20, v60, 63
s_nop 3
v_mov_b32 v61, 0x3acccccd
v_mul_f32 v61, s20, v61
v_sub_f32 v62, v64, v61
v_mul_f32 v60, v62, v62
v_sub_f32 v62, v65, v61
v_fmac_f32 v60, v62, v62
v_sub_f32 v62, v66, v61
v_fmac_f32 v60, v62, v62
v_sub_f32 v62, v67, v61
v_fmac_f32 v60, v62, v62
v_sub_f32 v62, v68, v61
v_fmac_f32 v60, v62, v62
v_sub_f32 v62, v69, v61
v_fmac_f32 v60, v62, v62
v_sub_f32 v62, v70, v61
v_fmac_f32 v60, v62, v62
v_sub_f32 v62, v71, v61
v_fmac_f32 v60, v62, v62
v_sub_f32 v62, v72, v61
v_fmac_f32 v60, v62, v62
v_sub_f32 v62, v73, v61
v_fmac_f32 v60, v62, v62
s_nop 1
v_add_f32_dpp v60, v60, v60 quad_perm:[1,0,3,2] row_mask:0xf bank_mask:0xf
s_nop 1
v_add_f32_dpp v60, v60, v60 quad_perm:[2,3,0,1] row_mask:0xf bank_mask:0xf
s_nop 1
v_add_f32_dpp v60, v60, v60 row_half_mirror row_mask:0xf bank_mask:0xf
s_nop 1
v_add_f32_dpp v60, v60, v60 row_mirror row_mask:0xf bank_mask:0xf
s_nop 1
v_add_f32_dpp v60, v60, v60 row_bcast:15 row_mask:0xa bank_mask:0xf
s_nop 1
v_add_f32_dpp v60, v60, v60 row_bcast:31 row_mask:0xc bank_mask:0xf
s_nop 1
v_readlane_b32 s21, v60, 63
s_nop 3
v_mov_b32 v62, 0x3acccccd
v_mul_f32 v62, s21, v62
v_cvt_pk_bf16_f32 v63, v61, v62
v_lshlrev_b32 v61, 16, v63
v_and_b32 v62, 0xffff0000, v63
v_add_f32 v62, 0x3727c5ac, v62
v_cvt_pk_bf16_f32 v63, v62, v62
v_lshlrev_b32 v62, 16, v63
v_sqrt_f32 v62, v62
s_nop 0
v_cvt_pk_bf16_f32 v63, v62, v62
v_lshlrev_b32 v62, 16, v63
v_rcp_f32 v63, v62
s_nop 0
v_sub_f32 v74, v64, v61
v_sub_f32 v75, v65, v61
v_sub_f32 v76, v66, v61
v_sub_f32 v77, v67, v61
v_sub_f32 v78, v68, v61
v_sub_f32 v79, v69, v61
v_sub_f32 v80, v70, v61
v_sub_f32 v81, v71, v61
v_sub_f32 v82, v72, v61
v_sub_f32 v83, v73, v61
v_cvt_pk_bf16_f32 v104, v74, v75
v_cvt_pk_bf16_f32 v105, v76, v77
v_cvt_pk_bf16_f32 v106, v78, v79
v_cvt_pk_bf16_f32 v107, v80, v81
v_cvt_pk_bf16_f32 v108, v82, v83
v_lshlrev_b32 v74, 16, v104
v_and_b32 v75, 0xffff0000, v104
v_lshlrev_b32 v76, 16, v105
v_and_b32 v77, 0xffff0000, v105
v_lshlrev_b32 v78, 16, v106
v_and_b32 v79, 0xffff0000, v106
v_lshlrev_b32 v80, 16, v107
v_and_b32 v81, 0xffff0000, v107
v_lshlrev_b32 v82, 16, v108
v_and_b32 v83, 0xffff0000, v108
v_mul_f32 v60, v74, v63
v_fma_f32 v74, -v60, v62, v74
v_fma_f32 v74, v74, v63, v60
v_mul_f32 v60, v75, v63
v_fma_f32 v75, -v60, v62, v75
v_fma_f32 v75, v75, v63, v60
v_mul_f32 v60, v76, v63
v_fma_f32 v76, -v60, v62, v76
v_fma_f32 v76, v76, v63, v60
v_mul_f32 v60, v77, v63
v_fma_f32 v77, -v60, v62, v77
v_fma_f32 v77, v77, v63, v60
v_mul_f32 v60, v78, v63
v_fma_f32 v78, -v60, v62, v78
v_fma_f32 v78, v78, v63, v60
v_mul_f32 v60, v79, v63
v_fma_f32 v79, -v60, v62, v79
v_fma_f32 v79, v79, v63, v60
v_mul_f32 v60, v80, v63
v_fma_f32 v80, -v60, v62, v80
v_fma_f32 v80, v80, v63, v60
v_mul_f32 v60, v81, v63
v_fma_f32 v81, -v60, v62, v81
v_fma_f32 v81, v81, v63, v60
v_mul_f32 v60, v82, v63
v_fma_f32 v82, -v60, v62, v82
v_fma_f32 v82, v82, v63, v60
v_mul_f32 v60, v83, v63
v_fma_f32 v83, -v60, v62, v83
v_fma_f32 v83, v83, v63, v60
v_cvt_pk_bf16_f32 v104, v74, v75
v_cvt_pk_bf16_f32 v105, v76, v77
v_cvt_pk_bf16_f32 v106, v78, v79
v_cvt_pk_bf16_f32 v107, v80, v81
v_cvt_pk_bf16_f32 v108, v82, v83
v_lshlrev_b32 v74, 16, v104
v_and_b32 v75, 0xffff0000, v104
v_lshlrev_b32 v76, 16, v105
v_and_b32 v77, 0xffff0000, v105
v_lshlrev_b32 v78, 16, v106
v_and_b32 v79, 0xffff0000, v106
v_lshlrev_b32 v80, 16, v107
v_and_b32 v81, 0xffff0000, v107
v_lshlrev_b32 v82, 16, v108
v_and_b32 v83, 0xffff0000, v108
s_waitcnt lgkmcnt(0)
v_lshlrev_b32 v84, 16, v16
v_and_b32 v85, 0xffff0000, v16
v_lshlrev_b32 v86, 16, v17
v_and_b32 v87, 0xffff0000, v17
v_lshlrev_b32 v88, 16, v18
v_and_b32 v89, 0xffff0000, v18
v_lshlrev_b32 v90, 16, v19
v_and_b32 v91, 0xffff0000, v19
v_lshlrev_b32 v92, 16, v20
v_and_b32 v93, 0xffff0000, v20
v_mul_f32 v74, v74, v84
v_mul_f32 v75, v75, v85
v_mul_f32 v76, v76, v86
v_mul_f32 v77, v77, v87
v_mul_f32 v78, v78, v88
v_mul_f32 v79, v79, v89
v_mul_f32 v80, v80, v90
v_mul_f32 v81, v81, v91
v_mul_f32 v82, v82, v92
v_mul_f32 v83, v83, v93
v_cvt_pk_bf16_f32 v104, v74, v75
v_cvt_pk_bf16_f32 v105, v76, v77
v_cvt_pk_bf16_f32 v106, v78, v79
v_cvt_pk_bf16_f32 v107, v80, v81
v_cvt_pk_bf16_f32 v108, v82, v83
v_lshlrev_b32 v74, 16, v104
v_and_b32 v75, 0xffff0000, v104
v_lshlrev_b32 v76, 16, v105
v_and_b32 v77, 0xffff0000, v105
v_lshlrev_b32 v78, 16, v106
v_and_b32 v79, 0xffff0000, v106
v_lshlrev_b32 v80, 16, v107
v_and_b32 v81, 0xffff0000, v107
v_lshlrev_b32 v82, 16, v108
v_and_b32 v83, 0xffff0000, v108
v_add_f32 v94, v64, v74
v_add_f32 v95, v65, v75
v_add_f32 v96, v66, v76
v_add_f32 v97, v67, v77
v_add_f32 v98, v68, v78
v_add_f32 v99, v69, v79
v_add_f32 v100, v70, v80
v_add_f32 v101, v71, v81
v_add_f32 v102, v72, v82
v_add_f32 v103, v73, v83
v_cvt_pk_bf16_f32 v104, v94, v95
v_cvt_pk_bf16_f32 v105, v96, v97
v_cvt_pk_bf16_f32 v106, v98, v99
v_cvt_pk_bf16_f32 v107, v100, v101
v_cvt_pk_bf16_f32 v108, v102, v103
v_lshlrev_b32 v94, 16, v104
v_and_b32 v95, 0xffff0000, v104
v_lshlrev_b32 v96, 16, v105
v_and_b32 v97, 0xffff0000, v105
v_lshlrev_b32 v98, 16, v106
v_and_b32 v99, 0xffff0000, v106
v_lshlrev_b32 v100, 16, v107
v_and_b32 v101, 0xffff0000, v107
v_lshlrev_b32 v102, 16, v108
v_and_b32 v103, 0xffff0000, v108
v_cvt_pk_bf16_f32 v112, v94, v95
v_cvt_pk_bf16_f32 v113, v96, v97
v_cvt_pk_bf16_f32 v114, v98, v99
v_cvt_pk_bf16_f32 v115, v100, v101
v_cvt_pk_bf16_f32 v116, v102, v103
buffer_store_dwordx4 v[112:115], v6, s[56:59], 0 offen
buffer_store_dword v116, v7, s[56:59], 0 offen
v_add_f32 v60, v94, v95
v_add_f32 v60, v60, v96
v_add_f32 v60, v60, v97
v_add_f32 v60, v60, v98
v_add_f32 v60, v60, v99
v_add_f32 v60, v60, v100
v_add_f32 v60, v60, v101
v_add_f32 v60, v60, v102
v_add_f32 v60, v60, v103
s_nop 1
v_add_f32_dpp v60, v60, v60 quad_perm:[1,0,3,2] row_mask:0xf bank_mask:0xf
s_nop 1
v_add_f32_dpp v60, v60, v60 quad_perm:[2,3,0,1] row_mask:0xf bank_mask:0xf
s_nop 1
v_add_f32_dpp v60, v60, v60 row_half_mirror row_mask:0xf bank_mask:0xf
s_nop 1
v_add_f32_dpp v60, v60, v60 row_mirror row_mask:0xf bank_mask:0xf
s_nop 1
v_add_f32_dpp v60, v60, v60 row_bcast:15 row_mask:0xa bank_mask:0xf
s_nop 1
v_add_f32_dpp v60, v60, v60 row_bcast:31 row_mask:0xc bank_mask:0xf
s_nop 1
v_readlane_b32 s22, v60, 63
s_nop 3
v_mov_b32 v61, 0x3acccccd
v_mul_f32 v61, s22, v61
v_sub_f32 v62, v94, v61
v_mul_f32 v60, v62, v62
v_sub_f32 v62, v95, v61
v_fmac_f32 v60, v62, v62
v_sub_f32 v62, v96, v61
v_fmac_f32 v60, v62, v62
v_sub_f32 v62, v97, v61
v_fmac_f32 v60, v62, v62
v_sub_f32 v62, v98, v61
v_fmac_f32 v60, v62, v62
v_sub_f32 v62, v99, v61
v_fmac_f32 v60, v62, v62
v_sub_f32 v62, v100, v61
v_fmac_f32 v60, v62, v62
v_sub_f32 v62, v101, v61
v_fmac_f32 v60, v62, v62
v_sub_f32 v62, v102, v61
v_fmac_f32 v60, v62, v62
v_sub_f32 v62, v103, v61
v_fmac_f32 v60, v62, v62
s_nop 1
v_add_f32_dpp v60, v60, v60 quad_perm:[1,0,3,2] row_mask:0xf bank_mask:0xf
s_nop 1
v_add_f32_dpp v60, v60, v60 quad_perm:[2,3,0,1] row_mask:0xf bank_mask:0xf
s_nop 1
v_add_f32_dpp v60, v60, v60 row_half_mirror row_mask:0xf bank_mask:0xf
s_nop 1
v_add_f32_dpp v60, v60, v60 row_mirror row_mask:0xf bank_mask:0xf
s_nop 1
v_add_f32_dpp v60, v60, v60 row_bcast:15 row_mask:0xa bank_mask:0xf
s_nop 1
v_add_f32_dpp v60, v60, v60 row_bcast:31 row_mask:0xc bank_mask:0xf
s_nop 1
v_readlane_b32 s23, v60, 63
s_nop 3
v_mov_b32 v62, 0x3acccccd
v_mul_f32 v62, s23, v62
v_cvt_pk_bf16_f32 v63, v61, v62
v_lshlrev_b32 v61, 16, v63
v_and_b32 v62, 0xffff0000, v63
v_add_f32 v62, 0x3727c5ac, v62
v_cvt_pk_bf16_f32 v63, v62, v62
v_lshlrev_b32 v62, 16, v63
v_sqrt_f32 v62, v62
s_nop 0
v_cvt_pk_bf16_f32 v63, v62, v62
v_lshlrev_b32 v62, 16, v63
v_rcp_f32 v63, v62
s_nop 0
v_sub_f32 v74, v94, v61
v_sub_f32 v75, v95, v61
v_sub_f32 v76, v96, v61
v_sub_f32 v77, v97, v61
v_sub_f32 v78, v98, v61
v_sub_f32 v79, v99, v61
v_sub_f32 v80, v100, v61
v_sub_f32 v81, v101, v61
v_sub_f32 v82, v102, v61
v_sub_f32 v83, v103, v61
v_cvt_pk_bf16_f32 v104, v74, v75
v_cvt_pk_bf16_f32 v105, v76, v77
v_cvt_pk_bf16_f32 v106, v78, v79
v_cvt_pk_bf16_f32 v107, v80, v81
v_cvt_pk_bf16_f32 v108, v82, v83
v_lshlrev_b32 v74, 16, v104
v_and_b32 v75, 0xffff0000, v104
v_lshlrev_b32 v76, 16, v105
v_and_b32 v77, 0xffff0000, v105
v_lshlrev_b32 v78, 16, v106
v_and_b32 v79, 0xffff0000, v106
v_lshlrev_b32 v80, 16, v107
v_and_b32 v81, 0xffff0000, v107
v_lshlrev_b32 v82, 16, v108
v_and_b32 v83, 0xffff0000, v108
v_mul_f32 v60, v74, v63
v_fma_f32 v74, -v60, v62, v74
v_fma_f32 v74, v74, v63, v60
v_mul_f32 v60, v75, v63
v_fma_f32 v75, -v60, v62, v75
v_fma_f32 v75, v75, v63, v60
v_mul_f32 v60, v76, v63
v_fma_f32 v76, -v60, v62, v76
v_fma_f32 v76, v76, v63, v60
v_mul_f32 v60, v77, v63
v_fma_f32 v77, -v60, v62, v77
v_fma_f32 v77, v77, v63, v60
v_mul_f32 v60, v78, v63
v_fma_f32 v78, -v60, v62, v78
v_fma_f32 v78, v78, v63, v60
v_mul_f32 v60, v79, v63
v_fma_f32 v79, -v60, v62, v79
v_fma_f32 v79, v79, v63, v60
v_mul_f32 v60, v80, v63
v_fma_f32 v80, -v60, v62, v80
v_fma_f32 v80, v80, v63, v60
v_mul_f32 v60, v81, v63
v_fma_f32 v81, -v60, v62, v81
v_fma_f32 v81, v81, v63, v60
v_mul_f32 v60, v82, v63
v_fma_f32 v82, -v60, v62, v82
v_fma_f32 v82, v82, v63, v60
v_mul_f32 v60, v83, v63
v_fma_f32 v83, -v60, v62, v83
v_fma_f32 v83, v83, v63, v60
v_cvt_pk_bf16_f32 v104, v74, v75
v_cvt_pk_bf16_f32 v105, v76, v77
v_cvt_pk_bf16_f32 v106, v78, v79
v_cvt_pk_bf16_f32 v107, v80, v81
v_cvt_pk_bf16_f32 v108, v82, v83
v_lshlrev_b32 v74, 16, v104
v_and_b32 v75, 0xffff0000, v104
v_lshlrev_b32 v76, 16, v105
v_and_b32 v77, 0xffff0000, v105
v_lshlrev_b32 v78, 16, v106
v_and_b32 v79, 0xffff0000, v106
v_lshlrev_b32 v80, 16, v107
v_and_b32 v81, 0xffff0000, v107
v_lshlrev_b32 v82, 16, v108
v_and_b32 v83, 0xffff0000, v108
v_cvt_pk_bf16_f32 v120, v74, v75
v_cvt_pk_bf16_f32 v121, v76, v77
v_cvt_pk_bf16_f32 v122, v78, v79
v_cvt_pk_bf16_f32 v123, v80, v81
v_cvt_pk_bf16_f32 v124, v82, v83
buffer_store_dwordx4 v[120:123], v6, s[60:63], 0 offen
buffer_store_dword v124, v7, s[60:63], 0 offen
s_waitcnt vmcnt(4)
v_lshlrev_b32 v84, 16, v24
v_and_b32 v85, 0xffff0000, v24
v_lshlrev_b32 v86, 16, v25
v_and_b32 v87, 0xffff0000, v25
v_lshlrev_b32 v88, 16, v26
v_and_b32 v89, 0xffff0000, v26
v_lshlrev_b32 v90, 16, v27
v_and_b32 v91, 0xffff0000, v27
v_lshlrev_b32 v92, 16, v28
v_and_b32 v93, 0xffff0000, v28
v_mul_f32 v60, v74, v84
v_fmac_f32 v60, v75, v85
v_fmac_f32 v60, v76, v86
v_fmac_f32 v60, v77, v87
v_fmac_f32 v60, v78, v88
v_fmac_f32 v60, v79, v89
v_fmac_f32 v60, v80, v90
v_fmac_f32 v60, v81, v91
v_fmac_f32 v60, v82, v92
v_fmac_f32 v60, v83, v93
s_nop 1
v_add_f32_dpp v60, v60, v60 quad_perm:[1,0,3,2] row_mask:0xf bank_mask:0xf
s_nop 1
v_add_f32_dpp v60, v60, v60 quad_perm:[2,3,0,1] row_mask:0xf bank_mask:0xf
s_nop 1
v_add_f32_dpp v60, v60, v60 row_half_mirror row_mask:0xf bank_mask:0xf
s_nop 1
v_add_f32_dpp v60, v60, v60 row_mirror row_mask:0xf bank_mask:0xf
s_nop 1
v_add_f32_dpp v60, v60, v60 row_bcast:15 row_mask:0xa bank_mask:0xf
s_nop 1
v_add_f32_dpp v60, v60, v60 row_bcast:31 row_mask:0xc bank_mask:0xf
s_nop 1
v_readlane_b32 s24, v60, 63
s_nop 3
v_add_f32 v64, v94, v74
v_add_f32 v65, v95, v75
v_add_f32 v66, v96, v76
v_add_f32 v67, v97, v77
v_add_f32 v68, v98, v78
v_add_f32 v69, v99, v79
v_add_f32 v70, v100, v80
v_add_f32 v71, v101, v81
v_add_f32 v72, v102, v82
v_add_f32 v73, v103, v83
v_cvt_pk_bf16_f32 v128, v64, v65
v_cvt_pk_bf16_f32 v129, v66, v67
v_cvt_pk_bf16_f32 v130, v68, v69
v_cvt_pk_bf16_f32 v131, v70, v71
v_cvt_pk_bf16_f32 v132, v72, v73
buffer_store_dwordx4 v[128:131], v6, s[48:51], 0 offen
buffer_store_dword v132, v7, s[48:51], 0 offen
v_mov_b32 v60, s24
v_cvt_pk_bf16_f32 v61, v60, v60
v_and_b32 v61, 0xffff, v61
v_xor_b32 v62, 0xffff, v61
v_or_b32 v63, 0x8000, v61
v_cmp_gt_u32 vcc, 0x8000, v61
s_nop 1
v_cndmask_b32 v61, v62, v63, vcc
v_lshlrev_b32 v61, 11, v61
v_sub_u32 v62, 2047, v2
v_or_b32 v61, v61, v62
v_lshlrev_b32 v62, 2, v2
v_cmp_eq_u32 vcc, 0, v1
s_and_saveexec_b64 s[30:31], vcc
buffer_store_dword v61, v62, s[64:67], 0 offen
K2_END:
s_endpgm
.globl ffn_kernel
.p2align 8
.type ffn_kernel,@function
ffn_kernel:
s_cmp_ge_u32 s2, 108
s_cbranch_scc1 K3_END
s_load_dwordx2 s[10:11], s[0:1], 88
s_load_dwordx4 s[12:15], s[0:1], 96
v_and_b32 v1, 63, v0
v_lshrrev_b32 v2, 6, v0
v_lshlrev_b32 v3, 5, v0
v_readfirstlane_b32 s18, v2
s_lshl_b32 s21, s2, 5
s_waitcnt lgkmcnt(0)
s_add_u32 s52, s14, 7864320
s_addc_u32 s53, s15, 0
s_mov_b32 s54, 8192
s_mov_b32 s55, 0x00020000
buffer_load_dwordx4 v[8:11], v3, s[52:55], 0 offen
buffer_load_dwordx4 v[12:15], v3, s[52:55], 0 offen offset:16
s_add_u32 s40, s14, 10530816
s_addc_u32 s41, s15, 0
s_mov_b32 s42, 4423680
s_mov_b32 s43, 0x00020000
s_add_u32 s60, s14, 14954496
s_addc_u32 s61, s15, 0
s_mov_b32 s62, 2211840
s_mov_b32 s63, 0x00020000
s_add_u32 s48, s14, 5242880
s_addc_u32 s49, s15, 0
s_mov_b32 s50, 2621440
s_mov_b32 s51, 0x00020000
s_add_u32 s56, s14, 7872512
s_addc_u32 s57, s15, 0
s_mov_b32 s58, 27648
s_mov_b32 s59, 0x00020000
s_mov_b32 s64, s10
s_mov_b32 s65, s11
s_mov_b32 s66, 2621440
s_mov_b32 s67, 0x00020000
s_add_u32 s68, s14, 2621440
s_addc_u32 s69, s15, 0
s_mov_b32 s70, 2621440
s_mov_b32 s71, 0x00020000
s_mov_b32 s72, s12
s_mov_b32 s73, s13
s_mov_b32 s74, 256
s_mov_b32 s75, 0x00020000
s_mul_i32 s19, s2, 40960
s_mul_i32 s20, s18, 5120
s_add_u32 s19, s19, s20
v_lshlrev_b32 v4, 4, v1
v_add_u32 v4, s19, v4
s_movk_i32 s22, 20480
buffer_load_dwordx4 v[64:67], v4, s[40:43], 0 offen offset:0
buffer_load_dwordx4 v[84:87], v4, s[40:43], s22 offen offset:0
buffer_load_dwordx4 v[68:71], v4, s[40:43], 0 offen offset:1024
buffer_load_dwordx4 v[88:91], v4, s[40:43], s22 offen offset:1024
buffer_load_dwordx4 v[72:75], v4, s[40:43], 0 offen offset:2048
buffer_load_dwordx4 v[92:95], v4, s[40:43], s22 offen offset:2048
buffer_load_dwordx4 v[76:79], v4, s[40:43], 0 offen offset:3072
buffer_load_dwordx4 v[96:99], v4, s[40:43], s22 offen offset:3072
v_add_u32 v5, 4096, v4
buffer_load_dwordx4 v[80:83], v5, s[40:43], 0 offen
buffer_load_dwordx4 v[100:103], v5, s[40:43], s22 offen
s_mul_i32 s27, s18, 14
s_cmp_eq_u32 s18, 3
s_cselect_b32 s28, 1, 0
s_sub_u32 s27, s27, s28
s_cmp_ge_u32 s2, 40
s_cbranch_scc1 K3_NOWD
s_mul_i32 s19, s2, 55296
s_lshl_b32 s20, s27, 10
s_add_u32 s19, s19, s20
v_lshlrev_b32 v6, 4, v1
v_add_u32 v6, s19, v6
s_movk_i32 s22, 0
buffer_load_dwordx4 v[136:139], v6, s[60:63], s22 offen offset:0
s_movk_i32 s22, 0
buffer_load_dwordx4 v[140:143], v6, s[60:63], s22 offen offset:1024
s_movk_i32 s22, 0
buffer_load_dwordx4 v[144:147], v6, s[60:63], s22 offen offset:2048
s_movk_i32 s22, 0
buffer_load_dwordx4 v[148:151], v6, s[60:63], s22 offen offset:3072
s_movk_i32 s22, 4096
buffer_load_dwordx4 v[152:155], v6, s[60:63], s22 offen offset:0
s_movk_i32 s22, 4096
buffer_load_dwordx4 v[156:159], v6, s[60:63], s22 offen offset:1024
s_movk_i32 s22, 4096
buffer_load_dwordx4 v[160:163], v6, s[60:63], s22 offen offset:2048
s_movk_i32 s22, 4096
buffer_load_dwordx4 v[164:167], v6, s[60:63], s22 offen offset:3072
s_movk_i32 s22, 8192
buffer_load_dwordx4 v[168:171], v6, s[60:63], s22 offen offset:0
s_movk_i32 s22, 8192
buffer_load_dwordx4 v[172:175], v6, s[60:63], s22 offen offset:1024
s_movk_i32 s22, 8192
buffer_load_dwordx4 v[176:179], v6, s[60:63], s22 offen offset:2048
s_movk_i32 s22, 8192
buffer_load_dwordx4 v[180:183], v6, s[60:63], s22 offen offset:3072
s_movk_i32 s22, 12288
buffer_load_dwordx4 v[184:187], v6, s[60:63], s22 offen offset:0
s_movk_i32 s22, 12288
buffer_load_dwordx4 v[188:191], v6, s[60:63], s22 offen offset:1024
s_waitcnt vmcnt(24)
s_branch K3_WDDONE
K3_NOWD:
s_waitcnt vmcnt(10)
K3_WDDONE:
v_mov_b32 v20, 0
v_max3_u32 v16, v8, v9, v10
v_max3_u32 v17, v11, v12, v13
v_max3_u32 v16, v16, v14, v15
v_max_u32 v16, v16, v17
s_nop 1
v_max_u32_dpp v16, v16, v16 quad_perm:[1,0,3,2] row_mask:0xf bank_mask:0xf
s_nop 1
v_max_u32_dpp v16, v16, v16 quad_perm:[2,3,0,1] row_mask:0xf bank_mask:0xf
s_nop 1
v_max_u32_dpp v16, v16, v16 row_half_mirror row_mask:0xf bank_mask:0xf
s_nop 1
v_max_u32_dpp v16, v16, v16 row_mirror row_mask:0xf bank_mask:0xf
s_nop 1
v_max_u32_dpp v16, v16, v16 row_bcast:15 row_mask:0xa bank_mask:0xf
s_nop 1
v_max_u32_dpp v16, v16, v16 row_bcast:31 row_mask:0xc bank_mask:0xf
s_nop 1
v_readlane_b32 s24, v16, 63
s_nop 3
v_writelane_b32 v20, s24, 0
v_cmp_ne_u32 vcc, s24, v8
s_nop 1
v_cndmask_b32 v8, 0, v8, vcc
v_cmp_ne_u32 vcc, s24, v9
s_nop 1
v_cndmask_b32 v9, 0, v9, vcc
v_cmp_ne_u32 vcc, s24, v10
s_nop 1
v_cndmask_b32 v10, 0, v10, vcc
v_cmp_ne_u32 vcc, s24, v11
s_nop 1
v_cndmask_b32 v11, 0, v11, vcc
v_cmp_ne_u32 vcc, s24, v12
s_nop 1
v_cndmask_b32 v12, 0, v12, vcc
v_cmp_ne_u32 vcc, s24, v13
s_nop 1
v_cndmask_b32 v13, 0, v13, vcc
v_cmp_ne_u32 vcc, s24, v14
s_nop 1
v_cndmask_b32 v14, 0, v14, vcc
v_cmp_ne_u32 vcc, s24, v15
s_nop 1
v_cndmask_b32 v15, 0, v15, vcc
v_max3_u32 v16, v8, v9, v10
v_max3_u32 v17, v11, v12, v13
v_max3_u32 v16, v16, v14, v15
v_max_u32 v16, v16, v17
s_nop 1
v_max_u32_dpp v16, v16, v16 quad_perm:[1,0,3,2] row_mask:0xf bank_mask:0xf
s_nop 1
v_max_u32_dpp v16, v16, v16 quad_perm:[2,3,0,1] row_mask:0xf bank_mask:0xf
s_nop 1
v_max_u32_dpp v16, v16, v16 row_half_mirror row_mask:0xf bank_mask:0xf
s_nop 1
v_max_u32_dpp v16, v16, v16 row_mirror row_mask:0xf bank_mask:0xf
s_nop 1
v_max_u32_dpp v16, v16, v16 row_bcast:15 row_mask:0xa bank_mask:0xf
s_nop 1
v_max_u32_dpp v16, v16, v16 row_bcast:31 row_mask:0xc bank_mask:0xf
s_nop 1
v_readlane_b32 s24, v16, 63
s_nop 3
v_writelane_b32 v20, s24, 1
v_cmp_ne_u32 vcc, s24, v8
s_nop 1
v_cndmask_b32 v8, 0, v8, vcc
v_cmp_ne_u32 vcc, s24, v9
s_nop 1
v_cndmask_b32 v9, 0, v9, vcc
v_cmp_ne_u32 vcc, s24, v10
s_nop 1
v_cndmask_b32 v10, 0, v10, vcc
v_cmp_ne_u32 vcc, s24, v11
s_nop 1
v_cndmask_b32 v11, 0, v11, vcc
v_cmp_ne_u32 vcc, s24, v12
s_nop 1
v_cndmask_b32 v12, 0, v12, vcc
v_cmp_ne_u32 vcc, s24, v13
s_nop 1
v_cndmask_b32 v13, 0, v13, vcc
v_cmp_ne_u32 vcc, s24, v14
s_nop 1
v_cndmask_b32 v14, 0, v14, vcc
v_cmp_ne_u32 vcc, s24, v15
s_nop 1
v_cndmask_b32 v15, 0, v15, vcc
v_max3_u32 v16, v8, v9, v10
v_max3_u32 v17, v11, v12, v13
v_max3_u32 v16, v16, v14, v15
v_max_u32 v16, v16, v17
s_nop 1
v_max_u32_dpp v16, v16, v16 quad_perm:[1,0,3,2] row_mask:0xf bank_mask:0xf
s_nop 1
v_max_u32_dpp v16, v16, v16 quad_perm:[2,3,0,1] row_mask:0xf bank_mask:0xf
s_nop 1
v_max_u32_dpp v16, v16, v16 row_half_mirror row_mask:0xf bank_mask:0xf
s_nop 1
v_max_u32_dpp v16, v16, v16 row_mirror row_mask:0xf bank_mask:0xf
s_nop 1
v_max_u32_dpp v16, v16, v16 row_bcast:15 row_mask:0xa bank_mask:0xf
s_nop 1
v_max_u32_dpp v16, v16, v16 row_bcast:31 row_mask:0xc bank_mask:0xf
s_nop 1
v_readlane_b32 s24, v16, 63
s_nop 3
v_writelane_b32 v20, s24, 2
v_cmp_ne_u32 vcc, s24, v8
s_nop 1
v_cndmask_b32 v8, 0, v8, vcc
v_cmp_ne_u32 vcc, s24, v9
s_nop 1
v_cndmask_b32 v9, 0, v9, vcc
v_cmp_ne_u32 vcc, s24, v10
s_nop 1
v_cndmask_b32 v10, 0, v10, vcc
v_cmp_ne_u32 vcc, s24, v11
s_nop 1
v_cndmask_b32 v11, 0, v11, vcc
v_cmp_ne_u32 vcc, s24, v12
s_nop 1
v_cndmask_b32 v12, 0, v12, vcc
v_cmp_ne_u32 vcc, s24, v13
s_nop 1
v_cndmask_b32 v13, 0, v13, vcc
v_cmp_ne_u32 vcc, s24, v14
s_nop 1
v_cndmask_b32 v14, 0, v14, vcc
v_cmp_ne_u32 vcc, s24, v15
s_nop 1
v_cndmask_b32 v15, 0, v15, vcc
v_max3_u32 v16, v8, v9, v10
v_max3_u32 v17, v11, v12, v13
v_max3_u32 v16, v16, v14, v15
v_max_u32 v16, v16, v17
s_nop 1
v_max_u32_dpp v16, v16, v16 quad_perm:[1,0,3,2] row_mask:0xf bank_mask:0xf
s_nop 1
v_max_u32_dpp v16, v16, v16 quad_perm:[2,3,0,1] row_mask:0xf bank_mask:0xf
s_nop 1
v_max_u32_dpp v16, v16, v16 row_half_mirror row_mask:0xf bank_mask:0xf
s_nop 1
v_max_u32_dpp v16, v16, v16 row_mirror row_mask:0xf bank_mask:0xf
s_nop 1
v_max_u32_dpp v16, v16, v16 row_bcast:15 row_mask:0xa bank_mask:0xf
s_nop 1
v_max_u32_dpp v16, v16, v16 row_bcast:31 row_mask:0xc bank_mask:0xf
s_nop 1
v_readlane_b32 s24, v16, 63
s_nop 3
v_writelane_b32 v20, s24, 3
v_cmp_ne_u32 vcc, s24, v8
s_nop 1
v_cndmask_b32 v8, 0, v8, vcc
v_cmp_ne_u32 vcc, s24, v9
s_nop 1
v_cndmask_b32 v9, 0, v9, vcc
v_cmp_ne_u32 vcc, s24, v10
s_nop 1
v_cndmask_b32 v10, 0, v10, vcc
v_cmp_ne_u32 vcc, s24, v11
s_nop 1
v_cndmask_b32 v11, 0, v11, vcc
v_cmp_ne_u32 vcc, s24, v12
s_nop 1
v_cndmask_b32 v12, 0, v12, vcc
v_cmp_ne_u32 vcc, s24, v13
s_nop 1
v_cndmask_b32 v13, 0, v13, vcc
v_cmp_ne_u32 vcc, s24, v14
s_nop 1
v_cndmask_b32 v14, 0, v14, vcc
v_cmp_ne_u32 vcc, s24, v15
s_nop 1
v_cndmask_b32 v15, 0, v15, vcc
v_max3_u32 v16, v8, v9, v10
v_max3_u32 v17, v11, v12, v13
v_max3_u32 v16, v16, v14, v15
v_max_u32 v16, v16, v17
s_nop 1
v_max_u32_dpp v16, v16, v16 quad_perm:[1,0,3,2] row_mask:0xf bank_mask:0xf
s_nop 1
v_max_u32_dpp v16, v16, v16 quad_perm:[2,3,0,1] row_mask:0xf bank_mask:0xf
s_nop 1
v_max_u32_dpp v16, v16, v16 row_half_mirror row_mask:0xf bank_mask:0xf
s_nop 1
v_max_u32_dpp v16, v16, v16 row_mirror row_mask:0xf bank_mask:0xf
s_nop 1
v_max_u32_dpp v16, v16, v16 row_bcast:15 row_mask:0xa bank_mask:0xf
s_nop 1
v_max_u32_dpp v16, v16, v16 row_bcast:31 row_mask:0xc bank_mask:0xf
s_nop 1
v_readlane_b32 s24, v16, 63
s_nop 3
v_writelane_b32 v20, s24, 4
v_cmp_ne_u32 vcc, s24, v8
s_nop 1
v_cndmask_b32 v8, 0, v8, vcc
v_cmp_ne_u32 vcc, s24, v9
s_nop 1
v_cndmask_b32 v9, 0, v9, vcc
v_cmp_ne_u32 vcc, s24, v10
s_nop 1
v_cndmask_b32 v10, 0, v10, vcc
v_cmp_ne_u32 vcc, s24, v11
s_nop 1
v_cndmask_b32 v11, 0, v11, vcc
v_cmp_ne_u32 vcc, s24, v12
s_nop 1
v_cndmask_b32 v12, 0, v12, vcc
v_cmp_ne_u32 vcc, s24, v13
s_nop 1
v_cndmask_b32 v13, 0, v13, vcc
v_cmp_ne_u32 vcc, s24, v14
s_nop 1
v_cndmask_b32 v14, 0, v14, vcc
v_cmp_ne_u32 vcc, s24, v15
s_nop 1
v_cndmask_b32 v15, 0, v15, vcc
v_max3_u32 v16, v8, v9, v10
v_max3_u32 v17, v11, v12, v13
v_max3_u32 v16, v16, v14, v15
v_max_u32 v16, v16, v17
s_nop 1
v_max_u32_dpp v16, v16, v16 quad_perm:[1,0,3,2] row_mask:0xf bank_mask:0xf
s_nop 1
v_max_u32_dpp v16, v16, v16 quad_perm:[2,3,0,1] row_mask:0xf bank_mask:0xf
s_nop 1
v_max_u32_dpp v16, v16, v16 row_half_mirror row_mask:0xf bank_mask:0xf
s_nop 1
v_max_u32_dpp v16, v16, v16 row_mirror row_mask:0xf bank_mask:0xf
s_nop 1
v_max_u32_dpp v16, v16, v16 row_bcast:15 row_mask:0xa bank_mask:0xf
s_nop 1
v_max_u32_dpp v16, v16, v16 row_bcast:31 row_mask:0xc bank_mask:0xf
s_nop 1
v_readlane_b32 s24, v16, 63
s_nop 3
v_writelane_b32 v20, s24, 5
v_cmp_ne_u32 vcc, s24, v8
s_nop 1
v_cndmask_b32 v8, 0, v8, vcc
v_cmp_ne_u32 vcc, s24, v9
s_nop 1
v_cndmask_b32 v9, 0, v9, vcc
v_cmp_ne_u32 vcc, s24, v10
s_nop 1
v_cndmask_b32 v10, 0, v10, vcc
v_cmp_ne_u32 vcc, s24, v11
s_nop 1
v_cndmask_b32 v11, 0, v11, vcc
v_cmp_ne_u32 vcc, s24, v12
s_nop 1
v_cndmask_b32 v12, 0, v12, vcc
v_cmp_ne_u32 vcc, s24, v13
s_nop 1
v_cndmask_b32 v13, 0, v13, vcc
v_cmp_ne_u32 vcc, s24, v14
s_nop 1
v_cndmask_b32 v14, 0, v14, vcc
v_cmp_ne_u32 vcc, s24, v15
s_nop 1
v_cndmask_b32 v15, 0, v15, vcc
v_max3_u32 v16, v8, v9, v10
v_max3_u32 v17, v11, v12, v13
v_max3_u32 v16, v16, v14, v15
v_max_u32 v16, v16, v17
s_nop 1
v_max_u32_dpp v16, v16, v16 quad_perm:[1,0,3,2] row_mask:0xf bank_mask:0xf
s_nop 1
v_max_u32_dpp v16, v16, v16 quad_perm:[2,3,0,1] row_mask:0xf bank_mask:0xf
s_nop 1
v_max_u32_dpp v16, v16, v16 row_half_mirror row_mask:0xf bank_mask:0xf
s_nop 1
v_max_u32_dpp v16, v16, v16 row_mirror row_mask:0xf bank_mask:0xf
s_nop 1
v_max_u32_dpp v16, v16, v16 row_bcast:15 row_mask:0xa bank_mask:0xf
s_nop 1
v_max_u32_dpp v16, v16, v16 row_bcast:31 row_mask:0xc bank_mask:0xf
s_nop 1
v_readlane_b32 s24, v16, 63
s_nop 3
v_writelane_b32 v20, s24, 6
v_cmp_ne_u32 vcc, s24, v8
s_nop 1
v_cndmask_b32 v8, 0, v8, vcc
v_cmp_ne_u32 vcc, s24, v9
s_nop 1
v_cndmask_b32 v9, 0, v9, vcc
v_cmp_ne_u32 vcc, s24, v10
s_nop 1
v_cndmask_b32 v10, 0, v10, vcc
v_cmp_ne_u32 vcc, s24, v11
s_nop 1
v_cndmask_b32 v11, 0, v11, vcc
v_cmp_ne_u32 vcc, s24, v12
s_nop 1
v_cndmask_b32 v12, 0, v12, vcc
v_cmp_ne_u32 vcc, s24, v13
s_nop 1
v_cndmask_b32 v13, 0, v13, vcc
v_cmp_ne_u32 vcc, s24, v14
s_nop 1
v_cndmask_b32 v14, 0, v14, vcc
v_cmp_ne_u32 vcc, s24, v15
s_nop 1
v_cndmask_b32 v15, 0, v15, vcc
v_max3_u32 v16, v8, v9, v10
v_max3_u32 v17, v11, v12, v13
v_max3_u32 v16, v16, v14, v15
v_max_u32 v16, v16, v17
s_nop 1
v_max_u32_dpp v16, v16, v16 quad_perm:[1,0,3,2] row_mask:0xf bank_mask:0xf
s_nop 1
v_max_u32_dpp v16, v16, v16 quad_perm:[2,3,0,1] row_mask:0xf bank_mask:0xf
s_nop 1
v_max_u32_dpp v16, v16, v16 row_half_mirror row_mask:0xf bank_mask:0xf
s_nop 1
v_max_u32_dpp v16, v16, v16 row_mirror row_mask:0xf bank_mask:0xf
s_nop 1
v_max_u32_dpp v16, v16, v16 row_bcast:15 row_mask:0xa bank_mask:0xf
s_nop 1
v_max_u32_dpp v16, v16, v16 row_bcast:31 row_mask:0xc bank_mask:0xf
s_nop 1
v_readlane_b32 s24, v16, 63
s_nop 3
v_writelane_b32 v20, s24, 7
s_lshl_b32 s23, s18, 5
v_lshlrev_b32 v21, 2, v1
v_add_u32 v21, s23, v21
v_cmp_gt_u32 vcc, 8, v1
s_and_saveexec_b64 s[30:31], vcc
ds_write_b32 v21, v20 offset:0
s_mov_b64 exec, s[30:31]
s_waitcnt lgkmcnt(0)
s_barrier
v_and_b32 v21, 31, v1
v_lshlrev_b32 v21, 2, v21
ds_read_b32 v22, v21 offset:0
v_mov_b32 v23, 0
ds_read_b128 v[24:27], v23 offset:0
ds_read_b128 v[28:31], v23 offset:16
ds_read_b128 v[32:35], v23 offset:32
ds_read_b128 v[36:39], v23 offset:48
ds_read_b128 v[40:43], v23 offset:64
ds_read_b128 v[44:47], v23 offset:80
ds_read_b128 v[48:51], v23 offset:96
ds_read_b128 v[52:55], v23 offset:112
s_waitcnt lgkmcnt(0)
v_mov_b32 v21, 0
v_cmp_gt_u32 vcc, v24, v22
s_nop 1
v_addc_co_u32 v21, vcc, 0, v21, vcc
v_cmp_gt_u32 vcc, v25, v22
s_nop 1
v_addc_co_u32 v21, vcc, 0, v21, vcc
v_cmp_gt_u32 vcc, v26, v22
s_nop 1
v_addc_co_u32 v21, vcc, 0, v21, vcc
v_cmp_gt_u32 vcc, v27, v22
s_nop 1
v_addc_co_u32 v21, vcc, 0, v21, vcc
v_cmp_gt_u32 vcc, v28, v22
s_nop 1
v_addc_co_u32 v21, vcc, 0, v21, vcc
v_cmp_gt_u32 vcc, v29, v22
s_nop 1
v_addc_co_u32 v21, vcc, 0, v21, vcc
v_cmp_gt_u32 vcc, v30, v22
s_nop 1
v_addc_co_u32 v21, vcc, 0, v21, vcc
v_cmp_gt_u32 vcc, v31, v22
s_nop 1
v_addc_co_u32 v21, vcc, 0, v21, vcc
v_cmp_gt_u32 vcc, v32, v22
s_nop 1
v_addc_co_u32 v21, vcc, 0, v21, vcc
v_cmp_gt_u32 vcc, v33, v22
s_nop 1
v_addc_co_u32 v21, vcc, 0, v21, vcc
v_cmp_gt_u32 vcc, v34, v22
s_nop 1
v_addc_co_u32 v21, vcc, 0, v21, vcc
v_cmp_gt_u32 vcc, v35, v22
s_nop 1
v_addc_co_u32 v21, vcc, 0, v21, vcc
v_cmp_gt_u32 vcc, v36, v22
s_nop 1
v_addc_co_u32 v21, vcc, 0, v21, vcc
v_cmp_gt_u32 vcc, v37, v22
s_nop 1
v_addc_co_u32 v21, vcc, 0, v21, vcc
v_cmp_gt_u32 vcc, v38, v22
s_nop 1
v_addc_co_u32 v21, vcc, 0, v21, vcc
v_cmp_gt_u32 vcc, v39, v22
s_nop 1
v_addc_co_u32 v21, vcc, 0, v21, vcc
v_cmp_gt_u32 vcc, v40, v22
s_nop 1
v_addc_co_u32 v21, vcc, 0, v21, vcc
v_cmp_gt_u32 vcc, v41, v22
s_nop 1
v_addc_co_u32 v21, vcc, 0, v21, vcc
v_cmp_gt_u32 vcc, v42, v22
s_nop 1
v_addc_co_u32 v21, vcc, 0, v21, vcc
v_cmp_gt_u32 vcc, v43, v22
s_nop 1
v_addc_co_u32 v21, vcc, 0, v21, vcc
v_cmp_gt_u32 vcc, v44, v22
s_nop 1
v_addc_co_u32 v21, vcc, 0, v21, vcc
v_cmp_gt_u32 vcc, v45, v22
s_nop 1
v_addc_co_u32 v21, vcc, 0, v21, vcc
v_cmp_gt_u32 vcc, v46, v22
s_nop 1
v_addc_co_u32 v21, vcc, 0, v21, vcc
v_cmp_gt_u32 vcc, v47, v22
s_nop 1
v_addc_co_u32 v21, vcc, 0, v21, vcc
v_cmp_gt_u32 vcc, v48, v22
s_nop 1
v_addc_co_u32 v21, vcc, 0, v21, vcc
v_cmp_gt_u32 vcc, v49, v22
s_nop 1
v_addc_co_u32 v21, vcc, 0, v21, vcc
v_cmp_gt_u32 vcc, v50, v22
s_nop 1
v_addc_co_u32 v21, vcc, 0, v21, vcc
v_cmp_gt_u32 vcc, v51, v22
s_nop 1
v_addc_co_u32 v21, vcc, 0, v21, vcc
v_cmp_gt_u32 vcc, v52, v22
s_nop 1
v_addc_co_u32 v21, vcc, 0, v21, vcc
v_cmp_gt_u32 vcc, v53, v22
s_nop 1
v_addc_co_u32 v21, vcc, 0, v21, vcc
v_cmp_gt_u32 vcc, v54, v22
s_nop 1
v_addc_co_u32 v21, vcc, 0, v21, vcc
v_cmp_gt_u32 vcc, v55, v22
s_nop 1
v_addc_co_u32 v21, vcc, 0, v21, vcc
v_lshlrev_b32 v23, 2, v21
v_cmp_gt_u32 vcc, 8, v21
s_and_saveexec_b64 s[30:31], vcc
ds_write_b32 v23, v22 offset:128
s_mov_b64 exec, s[30:31]
s_waitcnt lgkmcnt(0)
s_barrier
v_and_b32 v21, 7, v1
v_lshlrev_b32 v21, 2, v21
ds_read_b32 v22, v21 offset:128
v_lshrrev_b32 v61, 4, v0
v_and_b32 v61, 7, v61
v_lshlrev_b32 v61, 2, v61
ds_read_b32 v60, v61 offset:128
s_waitcnt lgkmcnt(0)
v_and_b32 v22, 2047, v22
v_sub_u32 v22, 2047, v22
s_movk_i32 s20, 1280
v_mul_lo_u32 v22, v22, s20
v_lshrrev_b32 v3, 4, v1
v_lshlrev_b32 v23, 4, v3
v_add_u32 v22, v22, v23
s_mul_i32 s19, s18, 320
v_add_u32 v22, s19, v22
buffer_load_dwordx4 v[104:107], v22, s[48:51], 0 offen offset:0
buffer_load_dwordx4 v[108:111], v22, s[48:51], 0 offen offset:64
buffer_load_dwordx4 v[112:115], v22, s[48:51], 0 offen offset:128
buffer_load_dwordx4 v[116:119], v22, s[48:51], 0 offen offset:192
buffer_load_dwordx4 v[120:123], v22, s[48:51], 0 offen offset:256
v_and_b32 v61, 2047, v60
v_sub_u32 v61, 2047, v61
v_mul_lo_u32 v61, v61, s20
v_and_b32 v62, 15, v0
v_lshlrev_b32 v62, 1, v62
v_add_u32 v61, v61, v62
v_add_u32 v61, s21, v61
buffer_load_ushort v62, v61, s[68:71], 0 offen
buffer_load_ushort v63, v61, s[48:51], 0 offen
v_and_b32 v2, 15, v1
v_mov_b32 v124, 0
v_mov_b32 v125, 0
v_mov_b32 v126, 0
v_mov_b32 v127, 0
v_mov_b32 v128, 0
v_mov_b32 v129, 0
v_mov_b32 v130, 0
v_mov_b32 v131, 0
s_waitcnt vmcnt(6)
v_mfma_f32_16x16x32_bf16 v[124:127], v[104:107], v[64:67], v[124:127]
v_mfma_f32_16x16x32_bf16 v[128:131], v[104:107], v[84:87], v[128:131]
s_waitcnt vmcnt(5)
v_mfma_f32_16x16x32_bf16 v[124:127], v[108:111], v[68:71], v[124:127]
v_mfma_f32_16x16x32_bf16 v[128:131], v[108:111], v[88:91], v[128:131]
s_waitcnt vmcnt(4)
v_mfma_f32_16x16x32_bf16 v[124:127], v[112:115], v[72:75], v[124:127]
v_mfma_f32_16x16x32_bf16 v[128:131], v[112:115], v[92:95], v[128:131]
s_waitcnt vmcnt(3)
v_mfma_f32_16x16x32_bf16 v[124:127], v[116:119], v[76:79], v[124:127]
v_mfma_f32_16x16x32_bf16 v[128:131], v[116:119], v[96:99], v[128:131]
s_waitcnt vmcnt(2)
v_mfma_f32_16x16x32_bf16 v[124:127], v[120:123], v[80:83], v[124:127]
v_mfma_f32_16x16x32_bf16 v[128:131], v[120:123], v[100:103], v[128:131]
s_nop 7
s_lshl_b32 s25, s18, 11
v_lshlrev_b32 v4, 8, v3
v_lshlrev_b32 v6, 2, v2
v_add_u32 v4, v4, v6
v_add_u32 v4, s25, v4
ds_write_b32 v4, v124 offset:256
ds_write_b32 v4, v125 offset:320
ds_write_b32 v4, v126 offset:384
ds_write_b32 v4, v127 offset:448
ds_write_b32 v4, v128 offset:1280
ds_write_b32 v4, v129 offset:1344
ds_write_b32 v4, v130 offset:1408
ds_write_b32 v4, v131 offset:1472
s_waitcnt lgkmcnt(0)
s_barrier
s_cmp_ge_u32 s18, 2
s_cbranch_scc1 K3_GUDONE
v_lshlrev_b32 v4, 2, v0
ds_read_b32 v8, v4 offset:256
ds_read_b32 v12, v4 offset:1280
ds_read_b32 v9, v4 offset:2304
ds_read_b32 v13, v4 offset:3328
ds_read_b32 v10, v4 offset:4352
ds_read_b32 v14, v4 offset:5376
ds_read_b32 v11, v4 offset:6400
ds_read_b32 v15, v4 offset:7424
s_waitcnt lgkmcnt(0)
v_add_f32 v8, v8, v9
v_add_f32 v10, v10, v11
v_add_f32 v8, v8, v10
v_add_f32 v12, v12, v13
v_add_f32 v14, v14, v15
v_add_f32 v9, v12, v14
v_cvt_pk_bf16_f32 v10, v8, v9
v_lshlrev_b32 v8, 16, v10
v_and_b32 v9, 0xffff0000, v10
v_mul_f32 v10, 0xbfb8aa3b, v8
v_exp_f32 v10, v10
s_nop 0
v_add_f32 v10, 1.0, v10
v_rcp_f32 v11, v10
s_nop 0
v_mul_f32 v12, v8, v11
v_fma_f32 v13, -v12, v10, v8
v_fma_f32 v12, v13, v11, v12
v_cvt_pk_bf16_f32 v13, v12, v12
v_lshlrev_b32 v12, 16, v13
v_mul_f32 v12, v12, v9
v_cvt_pk_bf16_f32 v13, v12, v12
v_lshrrev_b32 v5, 4, v0
s_movk_i32 s20, 3456
v_mul_lo_u32 v5, v5, s20
v_and_b32 v6, 15, v0
v_lshlrev_b32 v6, 1, v6
v_add_u32 v5, v5, v6
v_add_u32 v5, s21, v5
buffer_store_short v13, v5, s[56:59], 0 offen sc0 sc1
s_waitcnt vmcnt(0)
K3_GUDONE:
s_barrier
s_cmp_lg_u32 s18, 0
s_cbranch_scc1 K3_WAITWG
v_mov_b32 v8, 1
s_and_b32 s26, s2, 15
s_lshl_b32 s26, s26, 4
v_mov_b32 v9, s26
v_cmp_eq_u32 vcc, 0, v1
s_and_saveexec_b64 s[30:31], vcc
buffer_atomic_add v8, v9, s[72:75], 0 offen sc1
s_mov_b64 exec, s[30:31]
s_cmp_ge_u32 s2, 40
s_cbranch_scc1 K3_END
v_and_b32 v9, 15, v1
v_cmp_gt_u32 vcc, 12, v9
v_mov_b32 v11, 6
v_mov_b32 v12, 7
v_cndmask_b32 v11, v11, v12, vcc
v_lshlrev_b32 v9, 4, v9
K3_POLL:
buffer_load_dword v10, v9, s[72:75], 0 offen sc0 sc1
s_waitcnt vmcnt(0)
v_cmp_ge_u32 vcc, v10, v11
s_nop 3
s_cmp_eq_u64 vcc, exec
s_cbranch_scc1 K3_WAITWG
s_sleep 1
s_branch K3_POLL
K3_WAITWG:
s_cmp_ge_u32 s2, 40
s_cbranch_scc1 K3_END
s_barrier
v_lshlrev_b32 v22, 4, v0
s_movk_i32 s22, 0
buffer_load_dwordx4 v[64:67], v22, s[56:59], s22 offen sc1
s_movk_i32 s22, 4096
buffer_load_dwordx4 v[68:71], v22, s[56:59], s22 offen sc1
s_movk_i32 s22, 8192
buffer_load_dwordx4 v[72:75], v22, s[56:59], s22 offen sc1
s_movk_i32 s22, 12288
buffer_load_dwordx4 v[76:79], v22, s[56:59], s22 offen sc1
s_movk_i32 s22, 16384
buffer_load_dwordx4 v[80:83], v22, s[56:59], s22 offen sc1
s_movk_i32 s22, 20480
buffer_load_dwordx4 v[84:87], v22, s[56:59], s22 offen sc1
s_movk_i32 s22, 24576
buffer_load_dwordx4 v[88:91], v22, s[56:59], s22 offen sc1
v_add_u32 v23, 8448, v22
s_waitcnt vmcnt(6)
ds_write_b128 v23, v[64:67] offset:0
s_waitcnt vmcnt(5)
ds_write_b128 v23, v[68:71] offset:4096
s_waitcnt vmcnt(4)
ds_write_b128 v23, v[72:75] offset:8192
s_waitcnt vmcnt(3)
ds_write_b128 v23, v[76:79] offset:12288
s_waitcnt vmcnt(2)
ds_write_b128 v23, v[80:83] offset:16384
s_waitcnt vmcnt(1)
ds_write_b128 v23, v[84:87] offset:20480
s_waitcnt vmcnt(0)
ds_write_b128 v23, v[88:91] offset:24576
v_and_b32 v21, 7, v1
s_movk_i32 s20, 3456
v_mul_lo_u32 v22, v21, s20
v_lshlrev_b32 v23, 4, v3
v_add_u32 v22, v22, v23
s_lshl_b32 s29, s27, 6
s_add_u32 s29, s29, 8448
v_add_u32 v22, s29, v22
v_mov_b32 v124, 0
v_mov_b32 v125, 0
v_mov_b32 v126, 0
v_mov_b32 v127, 0
s_waitcnt lgkmcnt(0)
s_barrier
ds_read_b128 v[64:67], v22 offset:0
ds_read_b128 v[68:71], v22 offset:64
ds_read_b128 v[72:75], v22 offset:128
ds_read_b128 v[76:79], v22 offset:192
ds_read_b128 v[80:83], v22 offset:256
ds_read_b128 v[84:87], v22 offset:320
ds_read_b128 v[88:91], v22 offset:384
ds_read_b128 v[92:95], v22 offset:448
ds_read_b128 v[96:99], v22 offset:512
ds_read_b128 v[100:103], v22 offset:576
ds_read_b128 v[104:107], v22 offset:640
ds_read_b128 v[108:111], v22 offset:704
ds_read_b128 v[112:115], v22 offset:768
ds_read_b128 v[116:119], v22 offset:832
s_waitcnt lgkmcnt(13)
v_mfma_f32_16x16x32_bf16 v[124:127], v[64:67], v[136:139], v[124:127]
s_waitcnt lgkmcnt(12)
v_mfma_f32_16x16x32_bf16 v[124:127], v[68:71], v[140:143], v[124:127]
s_waitcnt lgkmcnt(11)
v_mfma_f32_16x16x32_bf16 v[124:127], v[72:75], v[144:147], v[124:127]
s_waitcnt lgkmcnt(10)
v_mfma_f32_16x16x32_bf16 v[124:127], v[76:79], v[148:151], v[124:127]
s_waitcnt lgkmcnt(9)
v_mfma_f32_16x16x32_bf16 v[124:127], v[80:83], v[152:155], v[124:127]
s_waitcnt lgkmcnt(8)
v_mfma_f32_16x16x32_bf16 v[124:127], v[84:87], v[156:159], v[124:127]
s_waitcnt lgkmcnt(7)
v_mfma_f32_16x16x32_bf16 v[124:127], v[88:91], v[160:163], v[124:127]
s_waitcnt lgkmcnt(6)
v_mfma_f32_16x16x32_bf16 v[124:127], v[92:95], v[164:167], v[124:127]
s_waitcnt lgkmcnt(5)
v_mfma_f32_16x16x32_bf16 v[124:127], v[96:99], v[168:171], v[124:127]
s_waitcnt lgkmcnt(4)
v_mfma_f32_16x16x32_bf16 v[124:127], v[100:103], v[172:175], v[124:127]
s_waitcnt lgkmcnt(3)
v_mfma_f32_16x16x32_bf16 v[124:127], v[104:107], v[176:179], v[124:127]
s_waitcnt lgkmcnt(2)
v_mfma_f32_16x16x32_bf16 v[124:127], v[108:111], v[180:183], v[124:127]
s_waitcnt lgkmcnt(1)
v_mfma_f32_16x16x32_bf16 v[124:127], v[112:115], v[184:187], v[124:127]
s_cmp_ge_u32 s18, 2
s_cbranch_scc1 K3_P2DONE
s_waitcnt lgkmcnt(0)
v_mfma_f32_16x16x32_bf16 v[124:127], v[116:119], v[188:191], v[124:127]
K3_P2DONE:
s_nop 7
s_lshl_b32 s25, s18, 10
v_lshlrev_b32 v4, 8, v3
v_lshlrev_b32 v6, 2, v2
v_add_u32 v4, v4, v6
v_add_u32 v4, s25, v4
ds_write_b32 v4, v124 offset:256
ds_write_b32 v4, v125 offset:320
ds_write_b32 v4, v126 offset:384
ds_write_b32 v4, v127 offset:448
s_waitcnt lgkmcnt(0)
s_barrier
s_cmp_ge_u32 s18, 2
s_cbranch_scc1 K3_END
v_lshlrev_b32 v4, 2, v0
ds_read_b32 v8, v4 offset:256
ds_read_b32 v9, v4 offset:1280
ds_read_b32 v10, v4 offset:2304
ds_read_b32 v11, v4 offset:3328
v_lshrrev_b32 v24, 11, v60
v_and_b32 v25, 0x7fff, v24
v_xor_b32 v26, 0xffff, v24
v_cmp_lt_u32 vcc, 0x7fff, v24
s_nop 1
v_cndmask_b32 v24, v26, v25, vcc
v_lshlrev_b32 v24, 16, v24
v_mul_f32 v25, 0xbfb8aa3b, v24
v_exp_f32 v25, v25
s_nop 0
v_add_f32 v25, 1.0, v25
v_rcp_f32 v26, v25
s_nop 0
v_fma_f32 v27, -v26, v25, 1.0
v_fma_f32 v26, v27, v26, v26
v_cvt_pk_bf16_f32 v27, v26, v26
v_lshlrev_b32 v26, 16, v27
s_waitcnt lgkmcnt(0)
v_add_f32 v8, v8, v9
v_add_f32 v10, v10, v11
v_add_f32 v8, v8, v10
v_cvt_pk_bf16_f32 v9, v8, v8
v_lshlrev_b32 v8, 16, v9
v_mul_f32 v8, v8, v26
v_cvt_pk_bf16_f32 v9, v8, v8
v_lshlrev_b32 v8, 16, v9
v_lshlrev_b32 v62, 16, v62
v_lshlrev_b32 v63, 16, v63
v_add_f32 v8, v8, v63
v_cvt_pk_bf16_f32 v9, v8, v8
v_lshlrev_b32 v8, 16, v9
v_add_f32 v8, v8, v62
v_cvt_pk_bf16_f32 v9, v8, v8
buffer_store_short v9, v61, s[64:67], 0 offen
K3_END:
s_endpgm
.section .rodata,"a"
.p2align 6
.amdhsa_kernel kvt_kernel
  .amdhsa_next_free_vgpr 96
  .amdhsa_next_free_sgpr 102
  .amdhsa_accum_offset 96
  .amdhsa_group_segment_fixed_size 0
  .amdhsa_kernarg_size 112
  .amdhsa_user_sgpr_count 2
  .amdhsa_user_sgpr_kernarg_segment_ptr 1
  .amdhsa_system_sgpr_workgroup_id_x 1
.end_amdhsa_kernel
.p2align 6
.amdhsa_kernel conv_kernel
  .amdhsa_next_free_vgpr 224
  .amdhsa_next_free_sgpr 102
  .amdhsa_accum_offset 224
  .amdhsa_group_segment_fixed_size 0
  .amdhsa_kernarg_size 112
  .amdhsa_user_sgpr_count 2
  .amdhsa_user_sgpr_kernarg_segment_ptr 1
  .amdhsa_system_sgpr_workgroup_id_x 1
.end_amdhsa_kernel
.p2align 6
.amdhsa_kernel rows_kernel
  .amdhsa_next_free_vgpr 136
  .amdhsa_next_free_sgpr 102
  .amdhsa_accum_offset 136
  .amdhsa_group_segment_fixed_size 0
  .amdhsa_kernarg_size 112
  .amdhsa_user_sgpr_count 2
  .amdhsa_user_sgpr_kernarg_segment_ptr 1
  .amdhsa_system_sgpr_workgroup_id_x 1
.end_amdhsa_kernel
.p2align 6
.amdhsa_kernel ffn_kernel
  .amdhsa_next_free_vgpr 192
  .amdhsa_next_free_sgpr 102
  .amdhsa_accum_offset 192
  .amdhsa_group_segment_fixed_size 0
  .amdhsa_kernarg_size 112
  .amdhsa_user_sgpr_count 2
  .amdhsa_user_sgpr_kernarg_segment_ptr 1
  .amdhsa_system_sgpr_workgroup_id_x 1
.end_amdhsa_kernel
```
